```python
import torch

def _softmax(x, axis=-1):
    return torch.softmax(x, dim=axis)
def _gelu(x):
    return torch.nn.functional.gelu(x, approximate="tanh")
def _silu(x):
    return torch.nn.functional.silu(x)
def _sigmoid(x):
    return torch.sigmoid(x)
def _layernorm(x, axis=-1, eps=1e-5):
    m = x.mean(dim=axis, keepdim=True)
    v = x.var(dim=axis, keepdim=True, unbiased=False)
    return (x - m) / torch.sqrt(v + eps)
def _scatter_add(tgt, idx, src, axis=0):
    return tgt.clone().index_add_(axis, idx, src)
def _segment_sum(src, seg, n):
    out = torch.zeros((n,) + src.shape[1:], dtype=src.dtype)
    return out.index_add_(0, seg, src)
def _pad(x, pw):
    flat = tuple(v for pair in reversed(pw) for v in pair)
    return torch.nn.functional.pad(x, flat)

kernel_name = 'gated_mix__mha_block__dense_activation_relu__prompt'

def setup_inputs():

    _w = (lambda a: (lambda t: t.to(torch.bfloat16) if t.is_floating_point() else t)(torch.as_tensor(a)))
    def _A_setup():
        B, S, D, H = 1, 2048, 640, 32
        return {
            "x": _w((lambda *s: torch.randn(*s, dtype=torch.bfloat16) * 0.05)(B, S, D)),
            "wqkv": _w((lambda *s: torch.randn(*s, dtype=torch.bfloat16) * 0.8)(D, 3 * D)),
            "wo": _w((lambda *s: torch.randn(*s, dtype=torch.bfloat16) * 0.2)(D, D)),
        }
    _A_in = _A_setup()

    def _B_setup():
        B, S, D, Dff = 1, 2048, 640, 1536
        return {
            "x": _w((lambda *s: torch.randn(*s, dtype=torch.bfloat16) * 0.05)(B, S, D)),
            "w1": _w((lambda *s: torch.randn(*s, dtype=torch.bfloat16) * 0.05)(D, Dff)),
            "w2": _w((lambda *s: torch.randn(*s, dtype=torch.bfloat16) * 0.05)(Dff, D)),
        }
    _B_in = _B_setup()

    return {
        "A_x": _A_in["x"],
        "A_wqkv": _A_in["wqkv"],
        "A_wo": _A_in["wo"],
        "B_x": _B_in["x"],
        "B_w1": _B_in["w1"],
        "B_w2": _B_in["w2"],
        "gate_w": _w((lambda *s: torch.randn(*s, dtype=torch.bfloat16) * 0.05)(640) * 16.0),
    }

def reference(A_x, A_wqkv, A_wo, B_x, B_w1, B_w2, gate_w):
    def _A_ref(x, wqkv, wo):
        B, S, D = x.shape
        H = 32
        Dh = D // H
        qkv = (lambda x, *d: x.permute(*d))((x @ wqkv).reshape(B, S, 3, H, Dh), 2, 0, 3, 1, 4)
        q, k, v = qkv[0], qkv[1], qkv[2]
        scores = torch.einsum("bhqd,bhkd->bhqk", q, k) * (Dh ** -0.5)
        p = _softmax(scores, axis=-1)
        o = torch.einsum("bhqk,bhkd->bhqd", p, v)
        return (lambda x, *d: x.permute(*d))(o, 0, 2, 1, 3).reshape(B, S, D) @ wo

    def _B_ref(x, w1, w2):
        h = torch.einsum("bsd,df->bsf", x, w1)
        zero = torch.zeros_like(h)
        h = torch.maximum(h, zero)
        return torch.einsum("bsf,fd->bsd", h, w2)

    x = A_x
    g = _sigmoid((x * gate_w).sum(-1, keepdims=True))
    a = _A_ref(x, A_wqkv, A_wo)
    b = _B_ref(x, B_w1, B_w2)
    return g * a + (1 - g) * b
```

```asm
; @launch grid=(256,1,1) block=(512,1,1) lds=163840
.amdgcn_target "amdgcn-amd-amdhsa--gfx950"
.text
.globl gated_mix__mha_block__dense_activation_relu__prompt_kernel
.p2align 8
.type gated_mix__mha_block__dense_activation_relu__prompt_kernel,@function
gated_mix__mha_block__dense_activation_relu__prompt_kernel:
    s_cmp_ge_u32 s2, 256
    s_cbranch_scc1 L_end
    s_load_dwordx2 s[4:5], s[0:1], 0
    s_load_dwordx2 s[8:9], s[0:1], 8
    s_load_dwordx2 s[12:13], s[0:1], 32
    s_load_dwordx2 s[20:21], s[0:1], 48
    s_load_dwordx2 s[16:17], s[0:1], 72
    s_load_dwordx2 s[52:53], s[0:1], 64
    s_load_dwordx2 s[46:47], s[0:1], 40
    s_load_dwordx2 s[48:49], s[0:1], 16
    s_load_dwordx2 s[50:51], s[0:1], 56
    v_and_b32 v236, 63, v0
    v_lshrrev_b32 v228, 6, v0
    s_and_b32 s31, s2, 7
    v_readfirstlane_b32 s24, v228
    s_lshr_b32 s32, s2, 3
    s_and_b32 s33, s32, 7
    s_lshr_b32 s32, s32, 3
    s_and_b32 s25, s31, 1
    s_lshl_b32 s25, s25, 3
    s_add_u32 s25, s25, s33
    s_lshr_b32 s26, s31, 1
    s_lshl_b32 s26, s26, 2
    s_add_u32 s26, s26, s32
    s_add_u32 s27, s32, s33
    s_mul_i32 s31, s27, 21846
    s_lshr_b32 s31, s31, 16
    s_mul_i32 s31, s31, 3
    s_sub_u32 s27, s27, s31
    s_mul_i32 s27, s27, 8
    s_lshr_b32 s27, s27, 1
    s_lshl_b32 s31, s26, 2
    s_mul_i32 s28, s26, 3
    s_add_u32 s28, s28, 12
    s_min_u32 s28, s28, s31
    s_lshl_b32 s30, s24, 11
    s_lshl_b32 s31, s25, 7
    s_lshl_b32 s32, s24, 4
    s_add_u32 s31, s31, s32
    v_lshrrev_b32 v228, 3, v236
    v_lshrrev_b32 v229, 4, v236
    v_and_b32 v230, 7, v236
    v_xor_b32 v230, v230, v229
    v_add_u32 v228, s31, v228
    v_mul_u32_u24 v228, 1280, v228
    v_lshl_add_u32 v216, v230, 4, v228
    v_xor_b32 v217, 64, v216
    v_add_u32 v217, 10240, v217
    v_bfe_u32 v232, v236, 2, 2
    v_xor_b32 v232, v232, v229
    v_and_b32 v230, 3, v236
    v_lshlrev_b32 v230, 4, v230
    v_lshl_add_u32 v230, v232, 6, v230
    s_lshl_b32 s31, s24, 3
    v_add_u32 v228, s31, v229
    v_mul_u32_u24 v231, 3840, v228
    s_lshl_b32 s31, s28, 6
    v_add3_u32 v218, v231, v230, s31
    v_cmp_eq_u32 vcc, 3, v232
    v_mov_b32 v233, 0x80000000
    s_cmp_ge_u32 s26, 12
    s_cselect_b64 s[36:37], vcc, 0
    s_lshr_b32 s34, s24, 2
    v_cndmask_b32 v218, v218, v233, s[36:37]
    s_waitcnt lgkmcnt(0)
    s_mov_b32 s6, 2621440
    s_mov_b32 s7, 0x00020000
    s_mov_b32 s10, 2457600
    s_mov_b32 s11, 0x00020000
    s_mov_b32 s29, s27
    s_lshl_b32 s31, s27, 7
    s_add_u32 m0, s30, 0
    s_mul_i32 s32, s27, 245760
    buffer_load_dwordx4 v216, s[4:7], s31 offen lds
    s_add_u32 m0, s30, 1024
    s_add_u32 s33, s32, 15360
    buffer_load_dwordx4 v217, s[4:7], s31 offen lds
    s_add_u32 m0, s30, 65536
    s_add_u32 s27, s27, 1
    buffer_load_dwordx4 v218, s[8:11], s32 offen lds
    s_add_u32 m0, s30, 66560
    s_cmp_eq_u32 s27, 10
    s_cselect_b32 s27, 0, s27
    buffer_load_dwordx4 v218, s[8:11], s33 offen lds
    s_and_b32 s35, s24, 3
    s_cmp_ge_u32 s26, 12
    s_cselect_b32 s38, s34, 0
    s_mov_b32 s22, 1280
    s_mov_b32 s23, 0x00020000
    s_cmp_eq_u32 s38, 1
    s_cbranch_scc1 L_gate
L_gate_ret:
    s_barrier
    s_lshl_b32 s31, s27, 7
    s_add_u32 m0, s30, 16384
    s_mul_i32 s32, s27, 245760
    buffer_load_dwordx4 v216, s[4:7], s31 offen lds
    s_add_u32 m0, s30, 17408
    s_add_u32 s33, s32, 15360
    buffer_load_dwordx4 v217, s[4:7], s31 offen lds
    s_add_u32 m0, s30, 81920
    s_add_u32 s27, s27, 1
    buffer_load_dwordx4 v218, s[8:11], s32 offen lds
    s_add_u32 m0, s30, 82944
    s_cmp_eq_u32 s27, 10
    s_cselect_b32 s27, 0, s27
    buffer_load_dwordx4 v218, s[8:11], s33 offen lds
    s_mov_b32 s14, 1966080
    s_mov_b32 s15, 0x00020000
    s_mov_b32 s18, 21659648
    s_mov_b32 s19, 0x00020000
    s_mov_b32 s54, 256
    s_mov_b32 s55, 0x00020000
    s_or_b32 s31, s2, s24
    s_cmp_eq_u32 s31, 0
    s_cbranch_scc1 L_tag
L_tag_ret:
    v_mul_u32_u24 v231, 3072, v228
    s_mul_i32 s31, s26, 192
    v_add3_u32 v219, v231, v230, s31
    v_cmp_eq_u32 vcc, 3, v232
    v_and_b32 v228, 31, v236
    s_lshl_b32 s31, s35, 5
    v_cndmask_b32 v219, v219, v233, vcc
    s_mul_i32 s32, s24, 15
    v_add_u32 v234, s32, v236
    v_mul_u32_u24 v229, 43, v234
    v_lshrrev_b32 v229, 8, v229
    v_mul_u32_u24 v230, 2304, v229
    v_lshl_add_u32 v230, v234, 7, v230
    s_lshr_b32 s32, s2, 3
    s_mul_i32 s32, s32, 61440
    s_bfe_u32 s33, s2, 0x20001
    s_mul_i32 s33, s33, 768
    s_add_u32 s32, s32, s33
    v_cmp_gt_u32 vcc, 120, v234
    v_add_u32 v230, s32, v230
    s_nop 0
    v_cndmask_b32 v254, v233, v230, vcc
    s_getpc_b64 s[98:99]
L_pc:
    s_sub_u32 s98, s98, L_pc-gated_mix__mha_block__dense_activation_relu__prompt_kernel
    s_subb_u32 s99, s99, 0
    s_lshr_b32 s32, s2, 3
    s_mul_i32 s32, s32, ((L_code_end-gated_mix__mha_block__dense_activation_relu__prompt_kernel+2047)/2048)
    v_min_u32 v229, ((L_code_end-gated_mix__mha_block__dense_activation_relu__prompt_kernel+2047)/2048)-1, v0
    v_add_u32 v229, s32, v229
    v_lshlrev_b32 v229, 6, v229
    v_min_u32 v251, L_code_end-gated_mix__mha_block__dense_activation_relu__prompt_kernel-4, v229
    v_add_u32 v228, s31, v228
    v_bfe_u32 v229, v228, 1, 3
    v_lshrrev_b32 v230, 5, v236
    v_xor_b32 v229, v229, v230
    v_lshlrev_b32 v229, 4, v229
    v_lshl_add_u32 v208, v228, 7, v229
    v_xor_b32 v209, 32, v208
    v_xor_b32 v210, 64, v208
    v_xor_b32 v211, 96, v208
    v_bfe_u32 v228, v236, 2, 2
    v_lshl_add_u32 v229, v230, 3, v228
    v_lshlrev_b32 v229, 8, v229
    v_bfe_u32 v231, v236, 4, 1
    v_lshl_add_u32 v229, v231, 5, v229
    v_and_b32 v231, 3, v236
    v_lshl_add_u32 v229, v231, 3, v229
    s_lshl_b32 s31, s34, 1
    s_add_u32 s31, s31, 0
    v_xor_b32 v231, s31, v228
    v_lshl_add_u32 v214, v231, 6, v229
    v_add_u32 v212, 0x10000, v214
    s_lshl_b32 s31, s34, 1
    s_add_u32 s31, s31, 1
    v_xor_b32 v231, s31, v228
    v_lshl_add_u32 v215, v231, 6, v229
    v_add_u32 v213, 0x10000, v215
    s_lshl_b32 s31, s35, 11
    s_add_u32 s31, s31, 131072
    v_lshl_add_u32 v237, v230, 4, s31
    s_and_b32 s31, s2, 7
    s_lshr_b32 s33, s2, 6
    s_bfe_u32 s32, s2, 0x30003
    s_lshr_b32 s39, s31, 1
    s_lshl_b32 s39, s39, 3
    s_add_u32 s39, s39, s32
    s_and_b32 s40, s31, 1
    s_lshl_b32 s40, s40, 2
    s_add_u32 s40, s40, s33
    s_mul_i32 s41, s40, 160
    v_mul_u32_u24 v229, 205, v0
    v_lshrrev_b32 v229, 11, v229
    v_mul_u32_u24 v230, 43, v229
    v_lshrrev_b32 v230, 10, v230
    v_mul_u32_u24 v234, 15360, v230
    v_mul_u32_u24 v229, 1120, v229
    v_lshl_add_u32 v229, v0, 4, v229
    s_mul_i32 s31, s39, 61440
    s_add_u32 s31, s31, s41
    s_mul_i32 s32, s39, 25600
    s_add_u32 s32, s32, s41
    v_cmp_gt_u32 vcc, 480, v0
    v_add_u32 v231, s31, v229
    v_add3_u32 v232, s32, v229, v234
    v_cndmask_b32 v252, v233, v231, vcc
    v_cmp_gt_u32 vcc, 280, v0
    s_nop 1
    v_cndmask_b32 v253, v233, v232, vcc
    v_lshrrev_b32 v230, 5, v236
    s_cmp_ge_u32 s26, 10
    s_cbranch_scc1 L_p1_v
    s_cmp_ge_u32 s26, 5
    s_cselect_b32 s31, 1, 0
    s_lshl_b32 s39, 81920, s31
    s_lshl_b32 s40, 5120, s31
    s_cmp_ge_u32 s26, 5
    s_cselect_b32 s41, 2621440, 0
    s_cselect_b32 s42, 20, 0
    s_mul_i32 s40, s40, s25
    s_add_u32 s40, s40, s41
    s_sub_u32 s42, s28, s42
    s_lshl_b32 s31, s34, 1
    s_add_u32 s42, s42, s31
    s_lshl_b32 s42, s42, 2
    s_and_b32 s31, s35, 1
    s_lshl_b32 s31, s31, 8
    s_add_u32 s40, s40, s31
    s_lshr_b32 s31, s35, 1
    s_lshl_b32 s41, s31, 11
    s_lshl_b32 s31, s31, 9
    s_add_u32 s33, s31, 4096
    v_and_b32 v228, 15, v236
    v_lshl_add_u32 v228, v228, 4, s40
    v_add_u32 v230, s42, v230
    v_bfe_u32 v233, v236, 4, 1
    v_lshl_add_u32 v234, v233, 10, s41
    v_mov_b32 v237, s33
    v_add_u32 v229, 0, v230
    v_mul_u32_u24 v231, 205, v229
    v_lshrrev_b32 v231, 10, v231
    v_mul_u32_u24 v232, 5, v231
    v_sub_u32 v229, v229, v232
    v_cmp_le_u32 vcc, 3, v229
    v_cmp_eq_u32 s[36:37], 2, v229
    v_subrev_u32 v235, 3, v229
    v_cndmask_b32 v232, 0, 1, vcc
    v_cndmask_b32 v229, v229, v235, vcc
    v_cndmask_b32 v232, v232, v233, s[36:37]
    v_lshl_add_u32 v231, v231, 1, v232
    v_mul_lo_u32 v231, v231, s39
    v_lshl_add_u32 v229, v229, 9, v234
    v_cndmask_b32 v229, v229, v237, s[36:37]
    v_add3_u32 v220, v228, v231, v229
    v_add_u32 v229, 2, v230
    v_mul_u32_u24 v231, 205, v229
    v_lshrrev_b32 v231, 10, v231
    v_mul_u32_u24 v232, 5, v231
    v_sub_u32 v229, v229, v232
    v_cmp_le_u32 vcc, 3, v229
    v_cmp_eq_u32 s[40:41], 2, v229
    v_subrev_u32 v235, 3, v229
    v_cndmask_b32 v232, 0, 1, vcc
    v_cndmask_b32 v229, v229, v235, vcc
    v_cndmask_b32 v232, v232, v233, s[40:41]
    v_lshl_add_u32 v231, v231, 1, v232
    v_mul_lo_u32 v231, v231, s39
    v_lshl_add_u32 v229, v229, 9, v234
    v_cndmask_b32 v229, v229, v237, s[40:41]
    v_add3_u32 v221, v228, v231, v229
    v_add_u32 v229, 4, v230
    v_mul_u32_u24 v231, 205, v229
    v_lshrrev_b32 v231, 10, v231
    v_mul_u32_u24 v232, 5, v231
    v_sub_u32 v229, v229, v232
    v_cmp_le_u32 vcc, 3, v229
    v_cmp_eq_u32 s[42:43], 2, v229
    v_subrev_u32 v235, 3, v229
    v_cndmask_b32 v232, 0, 1, vcc
    v_cndmask_b32 v229, v229, v235, vcc
    v_cndmask_b32 v232, v232, v233, s[42:43]
    v_lshl_add_u32 v231, v231, 1, v232
    v_mul_lo_u32 v231, v231, s39
    v_lshl_add_u32 v229, v229, 9, v234
    v_cndmask_b32 v229, v229, v237, s[42:43]
    v_add3_u32 v222, v228, v231, v229
    v_add_u32 v229, 6, v230
    v_mul_u32_u24 v231, 205, v229
    v_lshrrev_b32 v231, 10, v231
    v_mul_u32_u24 v232, 5, v231
    v_sub_u32 v229, v229, v232
    v_cmp_le_u32 vcc, 3, v229
    v_cmp_eq_u32 s[0:1], 2, v229
    v_subrev_u32 v235, 3, v229
    v_cndmask_b32 v232, 0, 1, vcc
    v_cndmask_b32 v229, v229, v235, vcc
    v_cndmask_b32 v232, v232, v233, s[0:1]
    v_lshl_add_u32 v231, v231, 1, v232
    v_mul_lo_u32 v231, v231, s39
    v_lshl_add_u32 v229, v229, 9, v234
    v_cndmask_b32 v229, v229, v237, s[0:1]
    v_add3_u32 v223, v228, v231, v229
    v_lshrrev_b32 v229, 1, v236
    v_xor_b32 v229, v229, v236
    v_and_b32 v229, 1, v229
    v_mul_u32_u24 v237, 24, v229
    v_xor_b32 v212, v212, v237
    v_xor_b32 v213, v213, v237
    s_lshl_b32 s31, s27, 7
    s_add_u32 m0, s30, 32768
    s_mul_i32 s32, s27, 245760
    buffer_load_dwordx4 v216, s[4:7], s31 offen lds
    s_add_u32 m0, s30, 33792
    s_add_u32 s33, s32, 15360
    buffer_load_dwordx4 v217, s[4:7], s31 offen lds
    s_add_u32 m0, s30, 98304
    s_add_u32 s27, s27, 1
    buffer_load_dwordx4 v218, s[8:11], s32 offen lds
    s_add_u32 m0, s30, 99328
    s_cmp_eq_u32 s27, 10
    s_cselect_b32 s27, 0, s27
    buffer_load_dwordx4 v218, s[8:11], s33 offen lds
    s_waitcnt vmcnt(8)
    s_barrier
    ds_read_b128 v[0:3], v208 offset:0
    ds_read_b64_tr_b16 v[192:193], v212 offset:0
    ds_read_b64_tr_b16 v[194:195], v212 offset:1024
    ds_read_b64_tr_b16 v[196:197], v213 offset:0
    ds_read_b64_tr_b16 v[198:199], v213 offset:1024
    ds_read_b128 v[4:7], v209 offset:0
    ds_read_b64_tr_b16 v[200:201], v212 offset:4096
    ds_read_b64_tr_b16 v[202:203], v212 offset:5120
    ds_read_b64_tr_b16 v[204:205], v213 offset:4096
    ds_read_b64_tr_b16 v[206:207], v213 offset:5120
    s_lshl_b32 s31, s27, 7
    s_add_u32 m0, s30, 49152
    s_mul_i32 s32, s27, 245760
    buffer_load_dwordx4 v216, s[4:7], s31 offen lds
L_site1:
    s_add_u32 m0, s30, 50176
    s_add_u32 s33, s32, 15360
    buffer_load_dwordx4 v217, s[4:7], s31 offen lds
L_site2:
    s_waitcnt lgkmcnt(7)
    v_mfma_f32_32x32x16_bf16 v[160:175], v[192:195], v[0:3], 0
    ds_read_b128 v[8:11], v210 offset:0
    ds_read_b64_tr_b16 v[228:229], v212 offset:8192
    ds_read_b64_tr_b16 v[230:231], v212 offset:9216
    s_add_u32 m0, s30, 114688
    s_add_u32 s27, s27, 1
    buffer_load_dwordx4 v218, s[8:11], s32 offen lds
L_site3:
    s_waitcnt lgkmcnt(8)
    v_mfma_f32_32x32x16_bf16 v[176:191], v[196:199], v[0:3], 0
    ds_read_b64_tr_b16 v[232:233], v213 offset:8192
    ds_read_b64_tr_b16 v[234:235], v213 offset:9216
    s_waitcnt lgkmcnt(7)
    v_mfma_f32_32x32x16_bf16 v[160:175], v[200:203], v[4:7], v[160:175]
    ds_read_b128 v[12:15], v211 offset:0
    ds_read_b64_tr_b16 v[192:193], v212 offset:12288
    ds_read_b64_tr_b16 v[194:195], v212 offset:13312
    s_add_u32 m0, s30, 115712
    s_cmp_eq_u32 s27, 10
    s_cselect_b32 s27, 0, s27
    buffer_load_dwordx4 v218, s[8:11], s33 offen lds
L_site4:
    s_waitcnt lgkmcnt(8)
    v_mfma_f32_32x32x16_bf16 v[176:191], v[204:207], v[4:7], v[176:191]
    ds_read_b64_tr_b16 v[196:197], v213 offset:12288
    ds_read_b64_tr_b16 v[198:199], v213 offset:13312
    s_waitcnt lgkmcnt(7)
    v_mfma_f32_32x32x16_bf16 v[160:175], v[228:231], v[8:11], v[160:175]
    s_waitcnt vmcnt(8) lgkmcnt(0)
    s_barrier
    ds_read_b128 v[16:19], v208 offset:16384
    ds_read_b64_tr_b16 v[200:201], v212 offset:16384
    ds_read_b64_tr_b16 v[202:203], v212 offset:17408
    s_lshl_b32 s31, s27, 7
    s_add_u32 m0, s30, 0
    s_mul_i32 s32, s27, 245760
    buffer_load_dwordx4 v216, s[4:7], s31 offen lds
L_site5:
    s_waitcnt lgkmcnt(8)
    v_mfma_f32_32x32x16_bf16 v[176:191], v[232:235], v[8:11], v[176:191]
    ds_read_b64_tr_b16 v[204:205], v213 offset:16384
    ds_read_b64_tr_b16 v[206:207], v213 offset:17408
    s_waitcnt lgkmcnt(7)
    v_mfma_f32_32x32x16_bf16 v[160:175], v[192:195], v[12:15], v[160:175]
    ds_read_b128 v[20:23], v209 offset:16384
    ds_read_b64_tr_b16 v[228:229], v212 offset:20480
    ds_read_b64_tr_b16 v[230:231], v212 offset:21504
    s_add_u32 m0, s30, 1024
    s_add_u32 s33, s32, 15360
    buffer_load_dwordx4 v217, s[4:7], s31 offen lds
L_site6:
    s_waitcnt lgkmcnt(8)
    v_mfma_f32_32x32x16_bf16 v[176:191], v[196:199], v[12:15], v[176:191]
    ds_read_b64_tr_b16 v[232:233], v213 offset:20480
    ds_read_b64_tr_b16 v[234:235], v213 offset:21504
    s_waitcnt lgkmcnt(7)
    v_mfma_f32_32x32x16_bf16 v[160:175], v[200:203], v[16:19], v[160:175]
    ds_read_b128 v[24:27], v210 offset:16384
    ds_read_b64_tr_b16 v[192:193], v212 offset:24576
    ds_read_b64_tr_b16 v[194:195], v212 offset:25600
    s_add_u32 m0, s30, 65536
    s_add_u32 s27, s27, 1
    buffer_load_dwordx4 v218, s[8:11], s32 offen lds
L_site7:
    s_waitcnt lgkmcnt(8)
    v_mfma_f32_32x32x16_bf16 v[176:191], v[204:207], v[16:19], v[176:191]
    ds_read_b64_tr_b16 v[196:197], v213 offset:24576
    ds_read_b64_tr_b16 v[198:199], v213 offset:25600
    s_waitcnt lgkmcnt(7)
    v_mfma_f32_32x32x16_bf16 v[160:175], v[228:231], v[20:23], v[160:175]
    ds_read_b128 v[28:31], v211 offset:16384
    ds_read_b64_tr_b16 v[200:201], v212 offset:28672
    ds_read_b64_tr_b16 v[202:203], v212 offset:29696
    s_add_u32 m0, s30, 66560
    s_cmp_eq_u32 s27, 10
    s_cselect_b32 s27, 0, s27
    buffer_load_dwordx4 v218, s[8:11], s33 offen lds
L_site8:
    s_waitcnt lgkmcnt(8)
    v_mfma_f32_32x32x16_bf16 v[176:191], v[232:235], v[20:23], v[176:191]
    ds_read_b64_tr_b16 v[204:205], v213 offset:28672
    ds_read_b64_tr_b16 v[206:207], v213 offset:29696
    s_waitcnt lgkmcnt(7)
    v_mfma_f32_32x32x16_bf16 v[160:175], v[192:195], v[24:27], v[160:175]
    s_waitcnt vmcnt(8) lgkmcnt(0)
    s_barrier
    ds_read_b128 v[32:35], v208 offset:32768
    ds_read_b64_tr_b16 v[228:229], v212 offset:32768
    ds_read_b64_tr_b16 v[230:231], v212 offset:33792
    s_lshl_b32 s31, s27, 7
    s_add_u32 m0, s30, 16384
    s_mul_i32 s32, s27, 245760
    buffer_load_dwordx4 v216, s[4:7], s31 offen lds
L_site9:
    s_waitcnt lgkmcnt(8)
    v_mfma_f32_32x32x16_bf16 v[176:191], v[196:199], v[24:27], v[176:191]
    ds_read_b64_tr_b16 v[232:233], v213 offset:32768
    ds_read_b64_tr_b16 v[234:235], v213 offset:33792
    s_waitcnt lgkmcnt(7)
    v_mfma_f32_32x32x16_bf16 v[160:175], v[200:203], v[28:31], v[160:175]
    ds_read_b128 v[36:39], v209 offset:32768
    ds_read_b64_tr_b16 v[192:193], v212 offset:36864
    ds_read_b64_tr_b16 v[194:195], v212 offset:37888
    s_add_u32 m0, s30, 17408
    s_add_u32 s33, s32, 15360
    buffer_load_dwordx4 v217, s[4:7], s31 offen lds
L_site10:
    s_waitcnt lgkmcnt(8)
    v_mfma_f32_32x32x16_bf16 v[176:191], v[204:207], v[28:31], v[176:191]
    ds_read_b64_tr_b16 v[196:197], v213 offset:36864
    ds_read_b64_tr_b16 v[198:199], v213 offset:37888
    s_waitcnt lgkmcnt(7)
    v_mfma_f32_32x32x16_bf16 v[160:175], v[228:231], v[32:35], v[160:175]
    ds_read_b128 v[40:43], v210 offset:32768
    ds_read_b64_tr_b16 v[200:201], v212 offset:40960
    ds_read_b64_tr_b16 v[202:203], v212 offset:41984
    s_add_u32 m0, s30, 81920
    s_add_u32 s27, s27, 1
    buffer_load_dwordx4 v218, s[8:11], s32 offen lds
L_site11:
    s_waitcnt lgkmcnt(8)
    v_mfma_f32_32x32x16_bf16 v[176:191], v[232:235], v[32:35], v[176:191]
    ds_read_b64_tr_b16 v[204:205], v213 offset:40960
    ds_read_b64_tr_b16 v[206:207], v213 offset:41984
    s_waitcnt lgkmcnt(7)
    v_mfma_f32_32x32x16_bf16 v[160:175], v[192:195], v[36:39], v[160:175]
    ds_read_b128 v[44:47], v211 offset:32768
    ds_read_b64_tr_b16 v[228:229], v212 offset:45056
    ds_read_b64_tr_b16 v[230:231], v212 offset:46080
    s_add_u32 m0, s30, 82944
    s_cmp_eq_u32 s27, 10
    s_cselect_b32 s27, 0, s27
    buffer_load_dwordx4 v218, s[8:11], s33 offen lds
L_site12:
    s_waitcnt lgkmcnt(8)
    v_mfma_f32_32x32x16_bf16 v[176:191], v[196:199], v[36:39], v[176:191]
    ds_read_b64_tr_b16 v[232:233], v213 offset:45056
    ds_read_b64_tr_b16 v[234:235], v213 offset:46080
    s_waitcnt lgkmcnt(7)
    v_mfma_f32_32x32x16_bf16 v[160:175], v[200:203], v[40:43], v[160:175]
    s_waitcnt vmcnt(8) lgkmcnt(0)
    s_barrier
    ds_read_b128 v[48:51], v208 offset:49152
    ds_read_b64_tr_b16 v[192:193], v212 offset:49152
    ds_read_b64_tr_b16 v[194:195], v212 offset:50176
    s_lshl_b32 s31, s27, 7
    s_add_u32 m0, s30, 32768
    s_mul_i32 s32, s27, 245760
    buffer_load_dwordx4 v216, s[4:7], s31 offen lds
L_site13:
    s_waitcnt lgkmcnt(8)
    v_mfma_f32_32x32x16_bf16 v[176:191], v[204:207], v[40:43], v[176:191]
    ds_read_b64_tr_b16 v[196:197], v213 offset:49152
    ds_read_b64_tr_b16 v[198:199], v213 offset:50176
    s_waitcnt lgkmcnt(7)
    v_mfma_f32_32x32x16_bf16 v[160:175], v[228:231], v[44:47], v[160:175]
    ds_read_b128 v[52:55], v209 offset:49152
    ds_read_b64_tr_b16 v[200:201], v212 offset:53248
    ds_read_b64_tr_b16 v[202:203], v212 offset:54272
    s_add_u32 m0, s30, 33792
    s_add_u32 s33, s32, 15360
    buffer_load_dwordx4 v217, s[4:7], s31 offen lds
L_site14:
    s_waitcnt lgkmcnt(8)
    v_mfma_f32_32x32x16_bf16 v[176:191], v[232:235], v[44:47], v[176:191]
    ds_read_b64_tr_b16 v[204:205], v213 offset:53248
    ds_read_b64_tr_b16 v[206:207], v213 offset:54272
    s_waitcnt lgkmcnt(7)
    v_mfma_f32_32x32x16_bf16 v[160:175], v[192:195], v[48:51], v[160:175]
    ds_read_b128 v[56:59], v210 offset:49152
    ds_read_b64_tr_b16 v[228:229], v212 offset:57344
    ds_read_b64_tr_b16 v[230:231], v212 offset:58368
    s_add_u32 m0, s30, 98304
    s_add_u32 s27, s27, 1
    buffer_load_dwordx4 v218, s[8:11], s32 offen lds
L_site15:
    s_waitcnt lgkmcnt(8)
    v_mfma_f32_32x32x16_bf16 v[176:191], v[196:199], v[48:51], v[176:191]
    ds_read_b64_tr_b16 v[232:233], v213 offset:57344
    ds_read_b64_tr_b16 v[234:235], v213 offset:58368
    s_waitcnt lgkmcnt(7)
    v_mfma_f32_32x32x16_bf16 v[160:175], v[200:203], v[52:55], v[160:175]
    ds_read_b128 v[60:63], v211 offset:49152
    ds_read_b64_tr_b16 v[192:193], v212 offset:61440
    ds_read_b64_tr_b16 v[194:195], v212 offset:62464
    s_add_u32 m0, s30, 99328
    s_cmp_eq_u32 s27, 10
    s_cselect_b32 s27, 0, s27
    buffer_load_dwordx4 v218, s[8:11], s33 offen lds
L_site16:
    s_waitcnt lgkmcnt(8)
    v_mfma_f32_32x32x16_bf16 v[176:191], v[204:207], v[52:55], v[176:191]
    ds_read_b64_tr_b16 v[196:197], v213 offset:61440
    ds_read_b64_tr_b16 v[198:199], v213 offset:62464
    s_waitcnt lgkmcnt(7)
    v_mfma_f32_32x32x16_bf16 v[160:175], v[228:231], v[56:59], v[160:175]
    s_waitcnt vmcnt(8) lgkmcnt(0)
    s_barrier
    ds_read_b128 v[64:67], v208 offset:0
    ds_read_b64_tr_b16 v[200:201], v212 offset:0
    ds_read_b64_tr_b16 v[202:203], v212 offset:1024
    s_lshl_b32 s31, s27, 7
    s_add_u32 m0, s30, 49152
    s_mul_i32 s32, s27, 245760
    buffer_load_dwordx4 v216, s[4:7], s31 offen lds
L_site17:
    s_waitcnt lgkmcnt(8)
    v_mfma_f32_32x32x16_bf16 v[176:191], v[232:235], v[56:59], v[176:191]
    ds_read_b64_tr_b16 v[204:205], v213 offset:0
    ds_read_b64_tr_b16 v[206:207], v213 offset:1024
    s_waitcnt lgkmcnt(7)
    v_mfma_f32_32x32x16_bf16 v[160:175], v[192:195], v[60:63], v[160:175]
    ds_read_b128 v[68:71], v209 offset:0
    ds_read_b64_tr_b16 v[228:229], v212 offset:4096
    ds_read_b64_tr_b16 v[230:231], v212 offset:5120
    s_add_u32 m0, s30, 50176
    s_add_u32 s33, s32, 15360
    buffer_load_dwordx4 v217, s[4:7], s31 offen lds
L_site18:
    s_waitcnt lgkmcnt(8)
    v_mfma_f32_32x32x16_bf16 v[176:191], v[196:199], v[60:63], v[176:191]
    ds_read_b64_tr_b16 v[232:233], v213 offset:4096
    ds_read_b64_tr_b16 v[234:235], v213 offset:5120
    s_waitcnt lgkmcnt(7)
    v_mfma_f32_32x32x16_bf16 v[160:175], v[200:203], v[64:67], v[160:175]
    ds_read_b128 v[72:75], v210 offset:0
    ds_read_b64_tr_b16 v[192:193], v212 offset:8192
    ds_read_b64_tr_b16 v[194:195], v212 offset:9216
    s_add_u32 m0, s30, 114688
    s_add_u32 s27, s27, 1
    buffer_load_dwordx4 v218, s[8:11], s32 offen lds
L_site19:
    s_waitcnt lgkmcnt(8)
    v_mfma_f32_32x32x16_bf16 v[176:191], v[204:207], v[64:67], v[176:191]
    ds_read_b64_tr_b16 v[196:197], v213 offset:8192
    ds_read_b64_tr_b16 v[198:199], v213 offset:9216
    s_waitcnt lgkmcnt(7)
    v_mfma_f32_32x32x16_bf16 v[160:175], v[228:231], v[68:71], v[160:175]
    ds_read_b128 v[76:79], v211 offset:0
    ds_read_b64_tr_b16 v[200:201], v212 offset:12288
    ds_read_b64_tr_b16 v[202:203], v212 offset:13312
    s_add_u32 m0, s30, 115712
    s_cmp_eq_u32 s27, 10
    s_cselect_b32 s27, 0, s27
    buffer_load_dwordx4 v218, s[8:11], s33 offen lds
    global_load_dword v251, v251, s[98:99]
L_site20:
    s_waitcnt lgkmcnt(8)
    v_mfma_f32_32x32x16_bf16 v[176:191], v[232:235], v[68:71], v[176:191]
    ds_read_b64_tr_b16 v[204:205], v213 offset:12288
    ds_read_b64_tr_b16 v[206:207], v213 offset:13312
    s_waitcnt lgkmcnt(7)
    v_mfma_f32_32x32x16_bf16 v[160:175], v[192:195], v[72:75], v[160:175]
    s_waitcnt vmcnt(9) lgkmcnt(0)
    s_barrier
    ds_read_b128 v[80:83], v208 offset:16384
    ds_read_b64_tr_b16 v[228:229], v212 offset:16384
    ds_read_b64_tr_b16 v[230:231], v212 offset:17408
    s_lshl_b32 s31, s27, 7
    s_add_u32 m0, s30, 0
    s_mul_i32 s32, s27, 245760
    buffer_load_dwordx4 v216, s[4:7], s31 offen lds
L_site21:
    s_waitcnt lgkmcnt(8)
    v_mfma_f32_32x32x16_bf16 v[176:191], v[196:199], v[72:75], v[176:191]
    ds_read_b64_tr_b16 v[232:233], v213 offset:16384
    ds_read_b64_tr_b16 v[234:235], v213 offset:17408
    s_waitcnt lgkmcnt(7)
    v_mfma_f32_32x32x16_bf16 v[160:175], v[200:203], v[76:79], v[160:175]
    ds_read_b128 v[84:87], v209 offset:16384
    ds_read_b64_tr_b16 v[192:193], v212 offset:20480
    ds_read_b64_tr_b16 v[194:195], v212 offset:21504
    s_add_u32 m0, s30, 1024
    s_add_u32 s33, s32, 15360
    buffer_load_dwordx4 v217, s[4:7], s31 offen lds
L_site22:
    s_waitcnt lgkmcnt(8)
    v_mfma_f32_32x32x16_bf16 v[176:191], v[204:207], v[76:79], v[176:191]
    ds_read_b64_tr_b16 v[196:197], v213 offset:20480
    ds_read_b64_tr_b16 v[198:199], v213 offset:21504
    s_waitcnt lgkmcnt(7)
    v_mfma_f32_32x32x16_bf16 v[160:175], v[228:231], v[80:83], v[160:175]
    ds_read_b128 v[88:91], v210 offset:16384
    ds_read_b64_tr_b16 v[200:201], v212 offset:24576
    ds_read_b64_tr_b16 v[202:203], v212 offset:25600
    s_add_u32 m0, s30, 65536
    s_add_u32 s27, s27, 1
    buffer_load_dwordx4 v218, s[8:11], s32 offen lds
L_site23:
    s_waitcnt lgkmcnt(8)
    v_mfma_f32_32x32x16_bf16 v[176:191], v[232:235], v[80:83], v[176:191]
    ds_read_b64_tr_b16 v[204:205], v213 offset:24576
    ds_read_b64_tr_b16 v[206:207], v213 offset:25600
    s_waitcnt lgkmcnt(7)
    v_mfma_f32_32x32x16_bf16 v[160:175], v[192:195], v[84:87], v[160:175]
    ds_read_b128 v[92:95], v211 offset:16384
    ds_read_b64_tr_b16 v[228:229], v212 offset:28672
    ds_read_b64_tr_b16 v[230:231], v212 offset:29696
    s_add_u32 m0, s30, 66560
    s_cmp_eq_u32 s27, 10
    s_cselect_b32 s27, 0, s27
    buffer_load_dwordx4 v218, s[8:11], s33 offen lds
L_site24:
    s_waitcnt lgkmcnt(8)
    v_mfma_f32_32x32x16_bf16 v[176:191], v[196:199], v[84:87], v[176:191]
    ds_read_b64_tr_b16 v[232:233], v213 offset:28672
    ds_read_b64_tr_b16 v[234:235], v213 offset:29696
    s_waitcnt lgkmcnt(7)
    v_mfma_f32_32x32x16_bf16 v[160:175], v[200:203], v[88:91], v[160:175]
    s_waitcnt vmcnt(9) lgkmcnt(0)
    s_barrier
    ds_read_b128 v[96:99], v208 offset:32768
    ds_read_b64_tr_b16 v[192:193], v212 offset:32768
    ds_read_b64_tr_b16 v[194:195], v212 offset:33792
    s_lshl_b32 s31, s27, 7
    s_add_u32 m0, s30, 16384
    s_mul_i32 s32, s27, 245760
    buffer_load_dwordx4 v216, s[4:7], s31 offen lds
L_site25:
    s_waitcnt lgkmcnt(8)
    v_mfma_f32_32x32x16_bf16 v[176:191], v[204:207], v[88:91], v[176:191]
    ds_read_b64_tr_b16 v[196:197], v213 offset:32768
    ds_read_b64_tr_b16 v[198:199], v213 offset:33792
    s_waitcnt lgkmcnt(7)
    v_mfma_f32_32x32x16_bf16 v[160:175], v[228:231], v[92:95], v[160:175]
    ds_read_b128 v[100:103], v209 offset:32768
    ds_read_b64_tr_b16 v[200:201], v212 offset:36864
    ds_read_b64_tr_b16 v[202:203], v212 offset:37888
    s_add_u32 m0, s30, 17408
    s_add_u32 s33, s32, 15360
    buffer_load_dwordx4 v217, s[4:7], s31 offen lds
L_site26:
    s_waitcnt lgkmcnt(8)
    v_mfma_f32_32x32x16_bf16 v[176:191], v[232:235], v[92:95], v[176:191]
    ds_read_b64_tr_b16 v[204:205], v213 offset:36864
    ds_read_b64_tr_b16 v[206:207], v213 offset:37888
    s_waitcnt lgkmcnt(7)
    v_mfma_f32_32x32x16_bf16 v[160:175], v[192:195], v[96:99], v[160:175]
    ds_read_b128 v[104:107], v210 offset:32768
    ds_read_b64_tr_b16 v[228:229], v212 offset:40960
    ds_read_b64_tr_b16 v[230:231], v212 offset:41984
    s_add_u32 m0, s30, 81920
    s_add_u32 s27, s27, 1
    buffer_load_dwordx4 v218, s[8:11], s32 offen lds
L_site27:
    s_waitcnt lgkmcnt(8)
    v_mfma_f32_32x32x16_bf16 v[176:191], v[196:199], v[96:99], v[176:191]
    ds_read_b64_tr_b16 v[232:233], v213 offset:40960
    ds_read_b64_tr_b16 v[234:235], v213 offset:41984
    s_waitcnt lgkmcnt(7)
    v_mfma_f32_32x32x16_bf16 v[160:175], v[200:203], v[100:103], v[160:175]
    ds_read_b128 v[108:111], v211 offset:32768
    ds_read_b64_tr_b16 v[192:193], v212 offset:45056
    ds_read_b64_tr_b16 v[194:195], v212 offset:46080
    s_add_u32 m0, s30, 82944
    s_cmp_eq_u32 s27, 10
    s_cselect_b32 s27, 0, s27
    buffer_load_dwordx4 v218, s[8:11], s33 offen lds
    buffer_load_dwordx2 v[238:239], off, s[52:55], 0
    s_mov_b32 exec_lo, 0x7fff
    s_mov_b32 exec_hi, 0x0
    buffer_load_dword v255, v254, s[12:15], 0 offen
    s_mov_b64 exec, -1
L_site28:
    s_waitcnt lgkmcnt(8)
    v_mfma_f32_32x32x16_bf16 v[176:191], v[204:207], v[100:103], v[176:191]
    ds_read_b64_tr_b16 v[196:197], v213 offset:45056
    ds_read_b64_tr_b16 v[198:199], v213 offset:46080
    s_waitcnt lgkmcnt(7)
    v_mfma_f32_32x32x16_bf16 v[160:175], v[228:231], v[104:107], v[160:175]
    s_waitcnt vmcnt(11) lgkmcnt(0)
    s_barrier
    ds_read_b128 v[112:115], v208 offset:49152
    ds_read_b64_tr_b16 v[200:201], v212 offset:49152
    ds_read_b64_tr_b16 v[202:203], v212 offset:50176
    s_waitcnt lgkmcnt(8)
    v_mfma_f32_32x32x16_bf16 v[176:191], v[232:235], v[104:107], v[176:191]
    ds_read_b64_tr_b16 v[204:205], v213 offset:49152
    ds_read_b64_tr_b16 v[206:207], v213 offset:50176
    s_waitcnt lgkmcnt(7)
    v_mfma_f32_32x32x16_bf16 v[160:175], v[192:195], v[108:111], v[160:175]
    ds_read_b128 v[116:119], v209 offset:49152
    ds_read_b64_tr_b16 v[228:229], v212 offset:53248
    ds_read_b64_tr_b16 v[230:231], v212 offset:54272
    s_waitcnt lgkmcnt(8)
    v_mfma_f32_32x32x16_bf16 v[176:191], v[196:199], v[108:111], v[176:191]
    ds_read_b64_tr_b16 v[232:233], v213 offset:53248
    ds_read_b64_tr_b16 v[234:235], v213 offset:54272
    s_waitcnt lgkmcnt(7)
    v_mfma_f32_32x32x16_bf16 v[160:175], v[200:203], v[112:115], v[160:175]
    ds_read_b128 v[120:123], v210 offset:49152
    ds_read_b64_tr_b16 v[192:193], v212 offset:57344
    ds_read_b64_tr_b16 v[194:195], v212 offset:58368
    s_waitcnt lgkmcnt(8)
    v_mfma_f32_32x32x16_bf16 v[176:191], v[204:207], v[112:115], v[176:191]
    ds_read_b64_tr_b16 v[196:197], v213 offset:57344
    ds_read_b64_tr_b16 v[198:199], v213 offset:58368
    s_waitcnt lgkmcnt(7)
    v_mfma_f32_32x32x16_bf16 v[160:175], v[228:231], v[116:119], v[160:175]
    ds_read_b128 v[124:127], v211 offset:49152
    ds_read_b64_tr_b16 v[200:201], v212 offset:61440
    ds_read_b64_tr_b16 v[202:203], v212 offset:62464
    s_waitcnt lgkmcnt(8)
    v_mfma_f32_32x32x16_bf16 v[176:191], v[232:235], v[116:119], v[176:191]
    ds_read_b64_tr_b16 v[204:205], v213 offset:61440
    ds_read_b64_tr_b16 v[206:207], v213 offset:62464
    s_waitcnt lgkmcnt(7)
    v_mfma_f32_32x32x16_bf16 v[160:175], v[192:195], v[120:123], v[160:175]
    s_waitcnt vmcnt(6) lgkmcnt(0)
    s_barrier
    ds_read_b128 v[128:131], v208 offset:0
    ds_read_b64_tr_b16 v[228:229], v212 offset:0
    ds_read_b64_tr_b16 v[230:231], v212 offset:1024
    s_mul_i32 s32, s27, 196608
    s_add_u32 m0, s30, 98304
    s_add_u32 s33, s32, 12288
    buffer_load_dwordx4 v219, s[12:15], s32 offen lds
L_site29:
    s_waitcnt lgkmcnt(8)
    v_mfma_f32_32x32x16_bf16 v[176:191], v[196:199], v[120:123], v[176:191]
    ds_read_b64_tr_b16 v[232:233], v213 offset:0
    ds_read_b64_tr_b16 v[234:235], v213 offset:1024
    s_waitcnt lgkmcnt(7)
    v_mfma_f32_32x32x16_bf16 v[160:175], v[200:203], v[124:127], v[160:175]
    ds_read_b128 v[132:135], v209 offset:0
    ds_read_b64_tr_b16 v[192:193], v212 offset:4096
    ds_read_b64_tr_b16 v[194:195], v212 offset:5120
    s_add_u32 m0, s30, 99328
    s_add_u32 s27, s27, 1
    s_cmp_eq_u32 s27, 10
    s_cselect_b32 s27, 0, s27
    buffer_load_dwordx4 v219, s[12:15], s33 offen lds
L_site30:
    s_waitcnt lgkmcnt(8)
    v_mfma_f32_32x32x16_bf16 v[176:191], v[204:207], v[124:127], v[176:191]
    ds_read_b64_tr_b16 v[196:197], v213 offset:4096
    ds_read_b64_tr_b16 v[198:199], v213 offset:5120
    s_waitcnt lgkmcnt(7)
    v_mfma_f32_32x32x16_bf16 v[160:175], v[228:231], v[128:131], v[160:175]
    ds_read_b128 v[136:139], v210 offset:0
    ds_read_b64_tr_b16 v[200:201], v212 offset:8192
    ds_read_b64_tr_b16 v[202:203], v212 offset:9216
    s_mul_i32 s32, s27, 196608
    s_add_u32 m0, s30, 32768
    s_add_u32 s33, s32, 12288
    buffer_load_dwordx4 v219, s[12:15], s32 offen lds
L_site31:
    s_waitcnt lgkmcnt(8)
    v_mfma_f32_32x32x16_bf16 v[176:191], v[232:235], v[128:131], v[176:191]
    ds_read_b64_tr_b16 v[204:205], v213 offset:8192
    ds_read_b64_tr_b16 v[206:207], v213 offset:9216
    s_waitcnt lgkmcnt(7)
    v_mfma_f32_32x32x16_bf16 v[160:175], v[192:195], v[132:135], v[160:175]
    ds_read_b128 v[140:143], v211 offset:0
    ds_read_b64_tr_b16 v[228:229], v212 offset:12288
    ds_read_b64_tr_b16 v[230:231], v212 offset:13312
    s_add_u32 m0, s30, 33792
    s_add_u32 s27, s27, 1
    s_cmp_eq_u32 s27, 10
    s_cselect_b32 s27, 0, s27
    buffer_load_dwordx4 v219, s[12:15], s33 offen lds
L_site32:
    s_waitcnt lgkmcnt(8)
    v_mfma_f32_32x32x16_bf16 v[176:191], v[196:199], v[132:135], v[176:191]
    ds_read_b64_tr_b16 v[232:233], v213 offset:12288
    ds_read_b64_tr_b16 v[234:235], v213 offset:13312
    s_waitcnt lgkmcnt(7)
    v_mfma_f32_32x32x16_bf16 v[160:175], v[200:203], v[136:139], v[160:175]
    s_waitcnt vmcnt(5) lgkmcnt(0)
    s_barrier
    ds_read_b128 v[144:147], v208 offset:16384
    ds_read_b64_tr_b16 v[192:193], v212 offset:16384
    ds_read_b64_tr_b16 v[194:195], v212 offset:17408
    s_mul_i32 s32, s27, 196608
    s_add_u32 m0, s30, 114688
    s_add_u32 s33, s32, 12288
    buffer_load_dwordx4 v219, s[12:15], s32 offen lds
L_site33:
    s_waitcnt lgkmcnt(8)
    v_mfma_f32_32x32x16_bf16 v[176:191], v[204:207], v[136:139], v[176:191]
    ds_read_b64_tr_b16 v[196:197], v213 offset:16384
    ds_read_b64_tr_b16 v[198:199], v213 offset:17408
    s_waitcnt lgkmcnt(7)
    v_mfma_f32_32x32x16_bf16 v[160:175], v[228:231], v[140:143], v[160:175]
    ds_read_b128 v[148:151], v209 offset:16384
    ds_read_b64_tr_b16 v[200:201], v212 offset:20480
    ds_read_b64_tr_b16 v[202:203], v212 offset:21504
    s_add_u32 m0, s30, 115712
    s_add_u32 s27, s27, 1
    s_cmp_eq_u32 s27, 10
    s_cselect_b32 s27, 0, s27
    buffer_load_dwordx4 v219, s[12:15], s33 offen lds
L_site34:
    s_waitcnt lgkmcnt(8)
    v_mfma_f32_32x32x16_bf16 v[176:191], v[232:235], v[140:143], v[176:191]
    ds_read_b64_tr_b16 v[204:205], v213 offset:20480
    ds_read_b64_tr_b16 v[206:207], v213 offset:21504
    s_waitcnt lgkmcnt(7)
    v_mfma_f32_32x32x16_bf16 v[160:175], v[192:195], v[144:147], v[160:175]
    ds_read_b128 v[152:155], v210 offset:16384
    ds_read_b64_tr_b16 v[228:229], v212 offset:24576
    ds_read_b64_tr_b16 v[230:231], v212 offset:25600
    s_mul_i32 s32, s27, 196608
    s_add_u32 m0, s30, 49152
    s_add_u32 s33, s32, 12288
    buffer_load_dwordx4 v219, s[12:15], s32 offen lds
L_site35:
    s_waitcnt lgkmcnt(8)
    v_mfma_f32_32x32x16_bf16 v[176:191], v[196:199], v[144:147], v[176:191]
    ds_read_b64_tr_b16 v[232:233], v213 offset:24576
    ds_read_b64_tr_b16 v[234:235], v213 offset:25600
    s_waitcnt lgkmcnt(7)
    v_mfma_f32_32x32x16_bf16 v[160:175], v[200:203], v[148:151], v[160:175]
    ds_read_b128 v[156:159], v211 offset:16384
    ds_read_b64_tr_b16 v[192:193], v212 offset:28672
    ds_read_b64_tr_b16 v[194:195], v212 offset:29696
    s_add_u32 m0, s30, 50176
    s_add_u32 s27, s27, 1
    s_cmp_eq_u32 s27, 10
    s_cselect_b32 s27, 0, s27
    buffer_load_dwordx4 v219, s[12:15], s33 offen lds
L_site36:
    s_waitcnt lgkmcnt(8)
    v_mfma_f32_32x32x16_bf16 v[176:191], v[204:207], v[148:151], v[176:191]
    ds_read_b64_tr_b16 v[196:197], v213 offset:28672
    ds_read_b64_tr_b16 v[198:199], v213 offset:29696
    s_waitcnt lgkmcnt(7)
    v_mfma_f32_32x32x16_bf16 v[160:175], v[228:231], v[152:155], v[160:175]
    s_waitcnt vmcnt(4) lgkmcnt(0)
    s_barrier
    s_waitcnt lgkmcnt(5)
    v_mfma_f32_32x32x16_bf16 v[176:191], v[232:235], v[152:155], v[176:191]
    s_waitcnt lgkmcnt(2)
    v_mfma_f32_32x32x16_bf16 v[160:175], v[192:195], v[156:159], v[160:175]
    s_waitcnt lgkmcnt(0)
    v_mfma_f32_32x32x16_bf16 v[176:191], v[196:199], v[156:159], v[176:191]
    s_cmp_ge_u32 s26, 5
    s_cselect_b32 s31, 1.0, 0x3ea52b5c
    s_mov_b32 s32, s31
    s_mov_b32 s33, s31
    v_xor_b32 v212, v212, v237
    v_xor_b32 v213, v213, v237
    s_nop 5
    v_pk_mul_f32 v[160:161], v[160:161], s[32:33]
    v_pk_mul_f32 v[162:163], v[162:163], s[32:33]
    v_pk_mul_f32 v[164:165], v[164:165], s[32:33]
    v_pk_mul_f32 v[166:167], v[166:167], s[32:33]
    v_cvt_pk_bf16_f32 v224, v160, v161
    v_cvt_pk_bf16_f32 v225, v162, v163
    v_cvt_pk_bf16_f32 v226, v164, v165
    v_cvt_pk_bf16_f32 v227, v166, v167
    s_mov_b64 exec, s[36:37]
    s_nop 0
    v_permlane16_swap_b32 v224, v226
    v_permlane16_swap_b32 v225, v227
    s_mov_b64 exec, -1
    buffer_store_dwordx4 v[224:227], v220, s[16:19], 0 offen sc1
    v_pk_mul_f32 v[168:169], v[168:169], s[32:33]
    v_pk_mul_f32 v[170:171], v[170:171], s[32:33]
    v_pk_mul_f32 v[172:173], v[172:173], s[32:33]
    v_pk_mul_f32 v[174:175], v[174:175], s[32:33]
    v_cvt_pk_bf16_f32 v240, v168, v169
    v_cvt_pk_bf16_f32 v241, v170, v171
    v_cvt_pk_bf16_f32 v242, v172, v173
    v_cvt_pk_bf16_f32 v243, v174, v175
    s_mov_b64 exec, s[40:41]
    s_nop 0
    v_permlane16_swap_b32 v240, v242
    v_permlane16_swap_b32 v241, v243
    s_mov_b64 exec, -1
    buffer_store_dwordx4 v[240:243], v221, s[16:19], 0 offen sc1
    v_pk_mul_f32 v[176:177], v[176:177], s[32:33]
    v_pk_mul_f32 v[178:179], v[178:179], s[32:33]
    v_pk_mul_f32 v[180:181], v[180:181], s[32:33]
    v_pk_mul_f32 v[182:183], v[182:183], s[32:33]
    v_cvt_pk_bf16_f32 v244, v176, v177
    v_cvt_pk_bf16_f32 v245, v178, v179
    v_cvt_pk_bf16_f32 v246, v180, v181
    v_cvt_pk_bf16_f32 v247, v182, v183
    s_mov_b64 exec, s[42:43]
    s_nop 0
    v_permlane16_swap_b32 v244, v246
    v_permlane16_swap_b32 v245, v247
    s_mov_b64 exec, -1
    buffer_store_dwordx4 v[244:247], v222, s[16:19], 0 offen sc1
    v_pk_mul_f32 v[184:185], v[184:185], s[32:33]
    v_pk_mul_f32 v[186:187], v[186:187], s[32:33]
    v_pk_mul_f32 v[188:189], v[188:189], s[32:33]
    v_pk_mul_f32 v[190:191], v[190:191], s[32:33]
    v_cvt_pk_bf16_f32 v248, v184, v185
    v_cvt_pk_bf16_f32 v249, v186, v187
    v_cvt_pk_bf16_f32 v250, v188, v189
    v_cvt_pk_bf16_f32 v251, v190, v191
    s_mov_b64 exec, s[0:1]
    s_nop 0
    v_permlane16_swap_b32 v248, v250
    v_permlane16_swap_b32 v249, v251
    s_mov_b64 exec, -1
    buffer_store_dwordx4 v[248:251], v223, s[16:19], 0 offen sc1
L_p2:
    v_readfirstlane_b32 s44, v238
    v_readfirstlane_b32 s45, v239
    s_nop 0
    s_cmp_eq_u32 s44, 0
    s_cbranch_scc1 L_tagw
L_tagw_ret:
    s_cmp_eq_u32 s34, 0
    s_cbranch_scc0 L_p2_1
    ds_read_b64_tr_b16 v[192:193], v212 offset:32768
    ds_read_b64_tr_b16 v[194:195], v212 offset:33792
    ds_read_b64_tr_b16 v[196:197], v213 offset:32768
    ds_read_b64_tr_b16 v[198:199], v213 offset:33792
    ds_read_b64_tr_b16 v[200:201], v212 offset:36864
    ds_read_b64_tr_b16 v[202:203], v212 offset:37888
    ds_read_b64_tr_b16 v[204:205], v213 offset:36864
    ds_read_b64_tr_b16 v[206:207], v213 offset:37888
    s_mov_b64 s[4:5], s[46:47]
    s_mov_b32 s6, 1966080
    s_mov_b64 s[8:9], s[48:49]
    s_mov_b32 s10, 819200
    s_waitcnt lgkmcnt(6)
    v_mfma_f32_32x32x16_bf16 v[160:175], v[192:195], v[0:3], 0
    ds_read_b64_tr_b16 v[228:229], v212 offset:40960
    ds_read_b64_tr_b16 v[230:231], v212 offset:41984
    s_mov_b32 s99, s30
    v_add_u32 v218, 12288, v219
    s_mov_b64 s[88:89], s[12:13]
    s_mov_b64 s[90:91], s[14:15]
    s_mul_i32 s92, s27, 196608
    s_add_u32 s27, s27, 1
    s_cmp_eq_u32 s27, 10
    s_cselect_b32 s27, 0, s27
    s_mul_i32 s93, s27, 196608
    s_add_u32 s27, s27, 1
    s_cmp_eq_u32 s27, 10
    s_cselect_b32 s27, 0, s27
    s_mul_i32 s94, s27, 196608
    s_add_u32 s27, s27, 1
    s_cmp_eq_u32 s27, 10
    s_cselect_b32 s27, 0, s27
    s_mul_i32 s95, s27, 196608
    s_add_u32 s27, s27, 1
    s_cmp_eq_u32 s27, 10
    s_cselect_b32 s27, 0, s27
    s_mul_i32 s96, s27, 196608
    s_add_u32 s27, s27, 1
    s_cmp_eq_u32 s27, 10
    s_cselect_b32 s27, 0, s27
    s_mul_i32 s97, s27, 196608
    s_add_u32 s27, s27, 1
    s_cmp_eq_u32 s27, 10
    s_cselect_b32 s27, 0, s27
    s_waitcnt lgkmcnt(6)
    v_mfma_f32_32x32x16_bf16 v[176:191], v[196:199], v[0:3], 0
    ds_read_b64_tr_b16 v[232:233], v213 offset:40960
    ds_read_b64_tr_b16 v[234:235], v213 offset:41984
    s_waitcnt lgkmcnt(6)
    v_mfma_f32_32x32x16_bf16 v[160:175], v[200:203], v[4:7], v[160:175]
    ds_read_b64_tr_b16 v[192:193], v212 offset:45056
    ds_read_b64_tr_b16 v[194:195], v212 offset:46080
    s_add_u32 m0, s99, 65536
    s_nop 0
    buffer_load_dwordx4 v219, s[88:91], s92 offen lds
    s_waitcnt lgkmcnt(6)
    v_mfma_f32_32x32x16_bf16 v[176:191], v[204:207], v[4:7], v[176:191]
    ds_read_b64_tr_b16 v[196:197], v213 offset:45056
    ds_read_b64_tr_b16 v[198:199], v213 offset:46080
    s_waitcnt lgkmcnt(6)
    v_mfma_f32_32x32x16_bf16 v[160:175], v[228:231], v[8:11], v[160:175]
    ds_read_b64_tr_b16 v[200:201], v214 offset:32768
    ds_read_b64_tr_b16 v[202:203], v214 offset:33792
    s_add_u32 m0, s99, 66560
    s_nop 0
    buffer_load_dwordx4 v218, s[88:91], s92 offen lds
    s_waitcnt lgkmcnt(6)
    v_mfma_f32_32x32x16_bf16 v[176:191], v[232:235], v[8:11], v[176:191]
    ds_read_b64_tr_b16 v[204:205], v215 offset:32768
    ds_read_b64_tr_b16 v[206:207], v215 offset:33792
    s_waitcnt lgkmcnt(6)
    v_mfma_f32_32x32x16_bf16 v[160:175], v[192:195], v[12:15], v[160:175]
    ds_read_b64_tr_b16 v[228:229], v214 offset:36864
    ds_read_b64_tr_b16 v[230:231], v214 offset:37888
    s_add_u32 m0, s99, 0
    s_nop 0
    buffer_load_dwordx4 v219, s[88:91], s93 offen lds
    s_waitcnt lgkmcnt(6)
    v_mfma_f32_32x32x16_bf16 v[176:191], v[196:199], v[12:15], v[176:191]
    ds_read_b64_tr_b16 v[232:233], v215 offset:36864
    ds_read_b64_tr_b16 v[234:235], v215 offset:37888
    s_waitcnt lgkmcnt(6)
    v_mfma_f32_32x32x16_bf16 v[160:175], v[200:203], v[16:19], v[160:175]
    ds_read_b64_tr_b16 v[192:193], v214 offset:40960
    ds_read_b64_tr_b16 v[194:195], v214 offset:41984
    s_waitcnt lgkmcnt(6)
    v_mfma_f32_32x32x16_bf16 v[176:191], v[204:207], v[16:19], v[176:191]
    ds_read_b64_tr_b16 v[196:197], v215 offset:40960
    ds_read_b64_tr_b16 v[198:199], v215 offset:41984
    s_waitcnt lgkmcnt(6)
    v_mfma_f32_32x32x16_bf16 v[160:175], v[228:231], v[20:23], v[160:175]
    ds_read_b64_tr_b16 v[200:201], v214 offset:45056
    ds_read_b64_tr_b16 v[202:203], v214 offset:46080
    s_add_u32 m0, s99, 1024
    s_nop 0
    buffer_load_dwordx4 v218, s[88:91], s93 offen lds
    s_waitcnt lgkmcnt(6)
    v_mfma_f32_32x32x16_bf16 v[176:191], v[232:235], v[20:23], v[176:191]
    ds_read_b64_tr_b16 v[204:205], v215 offset:45056
    ds_read_b64_tr_b16 v[206:207], v215 offset:46080
    s_waitcnt lgkmcnt(6)
    v_mfma_f32_32x32x16_bf16 v[160:175], v[192:195], v[24:27], v[160:175]
    s_waitcnt vmcnt(8) lgkmcnt(0)
    s_barrier
    ds_read_b64_tr_b16 v[228:229], v212 offset:49152
    ds_read_b64_tr_b16 v[230:231], v212 offset:50176
    s_add_u32 m0, s99, 81920
    s_nop 0
    buffer_load_dwordx4 v219, s[88:91], s94 offen lds
    s_waitcnt lgkmcnt(6)
    v_mfma_f32_32x32x16_bf16 v[176:191], v[196:199], v[24:27], v[176:191]
    ds_read_b64_tr_b16 v[232:233], v213 offset:49152
    ds_read_b64_tr_b16 v[234:235], v213 offset:50176
    s_waitcnt lgkmcnt(6)
    v_mfma_f32_32x32x16_bf16 v[160:175], v[200:203], v[28:31], v[160:175]
    ds_read_b64_tr_b16 v[192:193], v212 offset:53248
    ds_read_b64_tr_b16 v[194:195], v212 offset:54272
    s_add_u32 m0, s99, 82944
    s_nop 0
    buffer_load_dwordx4 v218, s[88:91], s94 offen lds
    v_lshlrev_b32 v255, 4, v236
    v_and_b32 v12, 0x1ff, v255
    s_lshl_b32 s31, s25, 2
    s_add_u32 s31, s31, s35
    s_waitcnt lgkmcnt(6)
    v_mfma_f32_32x32x16_bf16 v[176:191], v[204:207], v[28:31], v[176:191]
    ds_read_b64_tr_b16 v[196:197], v213 offset:53248
    ds_read_b64_tr_b16 v[198:199], v213 offset:54272
    s_mul_i32 s31, s31, 98304
    s_mul_i32 s32, s26, 3
    s_lshl_b32 s33, s34, 1
    s_add_u32 s32, s32, s33
    s_waitcnt lgkmcnt(6)
    v_mfma_f32_32x32x16_bf16 v[160:175], v[228:231], v[32:35], v[160:175]
    ds_read_b64_tr_b16 v[200:201], v212 offset:57344
    ds_read_b64_tr_b16 v[202:203], v212 offset:58368
    s_add_u32 m0, s99, 16384
    s_nop 0
    buffer_load_dwordx4 v219, s[88:91], s95 offen lds
    s_lshl_b32 s32, s32, 11
    s_add_u32 s31, s31, s32
    s_add_u32 s43, s31, 7864320
    s_lshl_b32 s39, s25, 7
    s_waitcnt lgkmcnt(6)
    v_mfma_f32_32x32x16_bf16 v[176:191], v[232:235], v[32:35], v[176:191]
    ds_read_b64_tr_b16 v[204:205], v213 offset:57344
    ds_read_b64_tr_b16 v[206:207], v213 offset:58368
    s_lshl_b32 s40, s26, 3
    s_add_u32 s39, s39, s40
    s_add_u32 s39, s39, 16818176
    s_cmp_eq_u32 s24, 0
    s_waitcnt lgkmcnt(6)
    v_mfma_f32_32x32x16_bf16 v[160:175], v[192:195], v[36:39], v[160:175]
    ds_read_b64_tr_b16 v[228:229], v212 offset:61440
    ds_read_b64_tr_b16 v[230:231], v212 offset:62464
    s_cselect_b32 s66, s39, 0x80000000
    s_lshl_b32 s39, s26, 7
    s_lshl_b32 s40, s25, 3
    s_add_u32 s39, s39, s40
    s_waitcnt lgkmcnt(6)
    v_mfma_f32_32x32x16_bf16 v[176:191], v[196:199], v[36:39], v[176:191]
    ds_read_b64_tr_b16 v[232:233], v213 offset:61440
    ds_read_b64_tr_b16 v[234:235], v213 offset:62464
    s_add_u32 s39, s39, 16785408
    s_cmp_eq_u32 s24, 4
    s_cselect_b32 s42, s39, 0x80000000
    s_mov_b32 s27, s34
    s_waitcnt lgkmcnt(6)
    v_mfma_f32_32x32x16_bf16 v[160:175], v[200:203], v[40:43], v[160:175]
    ds_read_b64_tr_b16 v[192:193], v214 offset:49152
    ds_read_b64_tr_b16 v[194:195], v214 offset:50176
    s_add_u32 m0, s99, 17408
    s_nop 0
    buffer_load_dwordx4 v218, s[88:91], s95 offen lds
    s_mov_b32 s28, s35
    s_mul_i32 s0, s27, 81920
    s_and_b32 s3, s24, 1
    s_sub_u32 s32, 3, s27
    s_waitcnt lgkmcnt(6)
    v_mfma_f32_32x32x16_bf16 v[176:191], v[204:207], v[40:43], v[176:191]
    ds_read_b64_tr_b16 v[196:197], v215 offset:49152
    ds_read_b64_tr_b16 v[198:199], v215 offset:50176
    s_mul_i32 s32, s32, s3
    s_mul_i32 s33, s27, 6
    s_add_u32 s12, s32, s33
    s_bfe_u32 s13, s24, 0x10001
    s_waitcnt lgkmcnt(6)
    v_mfma_f32_32x32x16_bf16 v[160:175], v[228:231], v[44:47], v[160:175]
    ds_read_b64_tr_b16 v[200:201], v214 offset:53248
    ds_read_b64_tr_b16 v[202:203], v214 offset:54272
    s_add_u32 m0, s99, 98304
    s_nop 0
    buffer_load_dwordx4 v219, s[88:91], s96 offen lds
    s_mul_i32 s32, s13, 81920
    s_lshl_b32 s12, s12, 10
    s_add_u32 s65, s32, s12
    s_mul_i32 s35, s3, 5120
    s_waitcnt lgkmcnt(6)
    v_mfma_f32_32x32x16_bf16 v[176:191], v[232:235], v[44:47], v[176:191]
    ds_read_b64_tr_b16 v[204:205], v215 offset:53248
    ds_read_b64_tr_b16 v[206:207], v215 offset:54272
    s_add_u32 s35, s35, s32
    s_mul_i32 s32, s13, 10240
    s_add_u32 s12, s12, s32
    s_and_b32 s31, s2, 7
    s_waitcnt lgkmcnt(6)
    v_mfma_f32_32x32x16_bf16 v[160:175], v[192:195], v[48:51], v[160:175]
    s_waitcnt vmcnt(9)
    s_barrier
    ds_read_b64_tr_b16 v[228:229], v214 offset:57344
    ds_read_b64_tr_b16 v[230:231], v214 offset:58368
    s_add_u32 m0, s99, 99328
    s_nop 0
    buffer_load_dwordx4 v218, s[88:91], s96 offen lds
    s_lshr_b32 s33, s2, 6
    s_bfe_u32 s26, s2, 0x30003
    s_lshl_b32 s25, s31, 2
    s_add_u32 s25, s25, s33
    s_waitcnt lgkmcnt(6)
    v_mfma_f32_32x32x16_bf16 v[176:191], v[196:199], v[48:51], v[176:191]
    ds_read_b64_tr_b16 v[232:233], v215 offset:57344
    ds_read_b64_tr_b16 v[234:235], v215 offset:58368
    s_mov_b32 s48, 0x11111111
    s_lshl_b32 s49, 0x101, s26
    s_lshl_b32 s39, s26, 8
    s_lshl_b32 s40, s25, 3
    s_waitcnt lgkmcnt(6)
    v_mfma_f32_32x32x16_bf16 v[160:175], v[200:203], v[52:55], v[160:175]
    ds_read_b64_tr_b16 v[192:193], v214 offset:61440
    ds_read_b64_tr_b16 v[194:195], v214 offset:62464
    s_add_u32 m0, s99, 32768
    s_nop 0
    buffer_load_dwordx4 v219, s[88:91], s97 offen lds
    s_add_u32 s39, s39, s40
    s_add_u32 s39, s39, 16850944
    s_cmp_eq_u32 s24, 0
    s_cselect_b32 s67, s39, 0x80000000
    s_waitcnt lgkmcnt(6)
    v_mfma_f32_32x32x16_bf16 v[176:191], v[204:207], v[52:55], v[176:191]
    ds_read_b64_tr_b16 v[196:197], v215 offset:61440
    ds_read_b64_tr_b16 v[198:199], v215 offset:62464
    v_lshrrev_b32 v0, 4, v236
    v_add_u32 v0, 1, v0
    v_mul_u32_u24 v1, 640, v0
    v_cmp_eq_u32 vcc, 3, v0
    s_waitcnt lgkmcnt(6)
    v_mfma_f32_32x32x16_bf16 v[160:175], v[228:231], v[56:59], v[160:175]
    s_waitcnt vmcnt(7)
    s_barrier
    ds_read_b64_tr_b16 v[200:201], v212 offset:0
    ds_read_b64_tr_b16 v[202:203], v212 offset:1024
    s_mul_i32 s39, s25, 20
    v_bfe_u32 v3, v236, 3, 1
    v_cndmask_b32 v1, v1, 0, vcc
    v_mul_u32_u24 v3, 19, v3
    s_waitcnt lgkmcnt(6)
    v_mfma_f32_32x32x16_bf16 v[176:191], v[232:235], v[56:59], v[176:191]
    ds_read_b64_tr_b16 v[204:205], v213 offset:0
    ds_read_b64_tr_b16 v[206:207], v213 offset:1024
    v_add3_u32 v1, v1, v3, s39
    v_min_u32 v1, 1919, v1
    v_lshrrev_b32 v1, 5, v1
    v_lshrrev_b32 v3, 2, v1
    s_waitcnt lgkmcnt(6)
    v_mfma_f32_32x32x16_bf16 v[160:175], v[192:195], v[60:63], v[160:175]
    ds_read_b64_tr_b16 v[228:229], v212 offset:4096
    ds_read_b64_tr_b16 v[230:231], v212 offset:5120
    s_add_u32 m0, s99, 33792
    s_nop 0
    buffer_load_dwordx4 v218, s[88:91], s97 offen lds
    v_subrev_u32 v4, 12, v1
    v_mul_u32_u24 v4, 43, v4
    v_lshrrev_b32 v4, 7, v4
    v_cmp_le_u32 vcc, 48, v1
    s_waitcnt lgkmcnt(6)
    v_mfma_f32_32x32x16_bf16 v[176:191], v[196:199], v[60:63], v[176:191]
    ds_read_b64_tr_b16 v[232:233], v213 offset:4096
    ds_read_b64_tr_b16 v[234:235], v213 offset:5120
    v_and_b32 v0, 7, v236
    v_lshlrev_b32 v0, 4, v0
    v_cndmask_b32 v3, v3, v4, vcc
    v_lshl_add_u32 v3, v3, 7, v0
    s_waitcnt lgkmcnt(6)
    v_mfma_f32_32x32x16_bf16 v[160:175], v[200:203], v[64:67], v[160:175]
    ds_read_b64_tr_b16 v[192:193], v212 offset:8192
    ds_read_b64_tr_b16 v[194:195], v212 offset:9216
    s_lshl_b32 m0, s24, 10
    s_add_u32 m0, m0, 151552
    s_nop 0
    buffer_load_dwordx4 v253, s[8:11], 0 offen lds
    v_add_u32 v254, 16785408, v3
    s_lshr_b32 s39, s31, 1
    s_lshl_b32 s39, s39, 3
    s_add_u32 s39, s39, s26
    s_waitcnt lgkmcnt(6)
    v_mfma_f32_32x32x16_bf16 v[176:191], v[204:207], v[64:67], v[176:191]
    ds_read_b64_tr_b16 v[196:197], v213 offset:8192
    ds_read_b64_tr_b16 v[198:199], v213 offset:9216
    s_and_b32 s40, s31, 1
    s_lshl_b32 s40, s40, 2
    s_add_u32 s40, s40, s33
    s_mul_i32 s36, s26, 3
    s_waitcnt lgkmcnt(6)
    v_mfma_f32_32x32x16_bf16 v[160:175], v[228:231], v[68:71], v[160:175]
    ds_read_b64_tr_b16 v[200:201], v212 offset:12288
    ds_read_b64_tr_b16 v[202:203], v212 offset:13312
    s_lshl_b32 m0, s24, 10
    s_add_u32 m0, m0, 143360
    s_nop 0
    buffer_load_dwordx4 v252, s[4:7], 0 offen lds
    s_lshr_b32 s36, s36, 1
    s_mul_i32 s33, s33, 3
    s_add_u32 s36, s36, s33
    s_cmp_ge_u32 s36, 12
    s_waitcnt lgkmcnt(6)
    v_mfma_f32_32x32x16_bf16 v[176:191], v[232:235], v[68:71], v[176:191]
    ds_read_b64_tr_b16 v[204:205], v213 offset:12288
    ds_read_b64_tr_b16 v[206:207], v213 offset:13312
    s_cselect_b32 s33, 12, 0
    s_sub_u32 s36, s36, s33
    s_lshr_b32 s33, s24, 1
    s_lshl_b32 s31, s33, 11
    s_waitcnt lgkmcnt(6)
    v_mfma_f32_32x32x16_bf16 v[160:175], v[192:195], v[72:75], v[160:175]
    ds_read_b64_tr_b16 v[228:229], v214 offset:0
    ds_read_b64_tr_b16 v[230:231], v214 offset:1024
    s_mul_i32 s58, s39, 196608
    s_add_u32 s58, s58, s31
    s_add_u32 s58, s58, 7864320
    s_add_u32 s62, s58, 98304
    s_waitcnt lgkmcnt(6)
    v_mfma_f32_32x32x16_bf16 v[176:191], v[196:199], v[72:75], v[176:191]
    ds_read_b64_tr_b16 v[232:233], v215 offset:0
    ds_read_b64_tr_b16 v[234:235], v215 offset:1024
    s_lshl_b32 s57, s36, 13
    s_add_u32 s57, s57, s58
    s_lshl_b32 s59, s39, 16
    s_add_u32 s59, s59, s31
    s_waitcnt lgkmcnt(6)
    v_mfma_f32_32x32x16_bf16 v[160:175], v[200:203], v[76:79], v[160:175]
    ds_read_b64_tr_b16 v[192:193], v214 offset:4096
    ds_read_b64_tr_b16 v[194:195], v214 offset:5120
    s_add_u32 s59, s59, 14155776
    s_lshl_b32 s15, s39, 2
    s_add_u32 s15, s15, s33
    s_lshl_b32 s15, s15, 12
    s_waitcnt lgkmcnt(6)
    v_mfma_f32_32x32x16_bf16 v[176:191], v[204:207], v[76:79], v[176:191]
    ds_read_b64_tr_b16 v[196:197], v215 offset:4096
    ds_read_b64_tr_b16 v[198:199], v215 offset:5120
    s_add_u32 s15, s15, 16252928
    s_lshl_b32 s31, s39, 2
    s_add_u32 s31, s31, s3
    s_lshl_b32 s64, s31, 6
    s_waitcnt lgkmcnt(6)
    v_mfma_f32_32x32x16_bf16 v[160:175], v[228:231], v[80:83], v[160:175]
    ds_read_b64_tr_b16 v[200:201], v214 offset:8192
    ds_read_b64_tr_b16 v[202:203], v214 offset:9216
    s_add_u32 s64, s64, 16777216
    s_mul_i32 s63, s31, 20480
    s_mul_i32 s41, s40, 160
    s_add_u32 s63, s63, s41
    s_waitcnt lgkmcnt(6)
    v_mfma_f32_32x32x16_bf16 v[176:191], v[232:235], v[80:83], v[176:191]
    ds_read_b64_tr_b16 v[204:205], v215 offset:8192
    ds_read_b64_tr_b16 v[206:207], v215 offset:9216
    s_mul_i32 s1, s40, 348160
    s_add_u32 s1, s1, 18874368
    s_add_u32 s60, s1, s12
    s_add_u32 s61, s60, 245760
    s_waitcnt lgkmcnt(6)
    v_mfma_f32_32x32x16_bf16 v[160:175], v[192:195], v[84:87], v[160:175]
    ds_read_b64_tr_b16 v[228:229], v214 offset:12288
    ds_read_b64_tr_b16 v[230:231], v214 offset:13312
    s_mul_i32 s56, s36, 20480
    s_add_u32 s56, s56, s60
    s_lshl_b32 s31, s24, 6
    v_add_u32 v0, s31, v236
    s_waitcnt lgkmcnt(6)
    v_mfma_f32_32x32x16_bf16 v[176:191], v[196:199], v[84:87], v[176:191]
    ds_read_b64_tr_b16 v[232:233], v215 offset:12288
    ds_read_b64_tr_b16 v[234:235], v215 offset:13312
    v_mov_b32 v5, 0x80000000
    v_mul_u32_u24 v1, 205, v0
    v_lshrrev_b32 v1, 15, v1
    v_lshrrev_b32 v2, 5, v0
    s_waitcnt lgkmcnt(6)
    v_mfma_f32_32x32x16_bf16 v[160:175], v[200:203], v[88:91], v[160:175]
    s_waitcnt vmcnt(6)
    s_barrier
    ds_read_b64_tr_b16 v[192:193], v212 offset:16384
    ds_read_b64_tr_b16 v[194:195], v212 offset:17408
    v_bfe_u32 v3, v236, 2, 3
    v_mul_u32_u24 v3, 160, v3
    v_and_b32 v4, 3, v236
    v_lshl_add_u32 v3, v4, 3, v3
    s_waitcnt lgkmcnt(6)
    v_mfma_f32_32x32x16_bf16 v[176:191], v[204:207], v[88:91], v[176:191]
    ds_read_b64_tr_b16 v[196:197], v213 offset:16384
    ds_read_b64_tr_b16 v[198:199], v213 offset:17408
    v_lshl_add_u32 v4, v2, 5, v3
    v_add_u32 v241, 151552, v4
    v_mul_u32_u24 v6, 2400, v1
    v_add_u32 v4, 143360, v4
    s_waitcnt lgkmcnt(6)
    v_mfma_f32_32x32x16_bf16 v[160:175], v[228:231], v[92:95], v[160:175]
    ds_read_b64_tr_b16 v[200:201], v212 offset:20480
    ds_read_b64_tr_b16 v[202:203], v212 offset:21504
    v_add_u32 v240, v4, v6
    v_and_b32 v4, 0x1ff, v255
    v_lshl_add_u32 v2, v2, 10, v4
    s_mul_i32 s32, s39, 3
    s_waitcnt lgkmcnt(6)
    v_mfma_f32_32x32x16_bf16 v[176:191], v[232:235], v[92:95], v[176:191]
    ds_read_b64_tr_b16 v[204:205], v213 offset:20480
    ds_read_b64_tr_b16 v[206:207], v213 offset:21504
    v_add_u32 v4, s32, v1
    v_lshrrev_b32 v6, 1, v4
    v_sub_u32 v6, v6, v1
    v_mul_u32_u24 v6, 5120, v6
    s_waitcnt lgkmcnt(6)
    v_mfma_f32_32x32x16_bf16 v[160:175], v[192:195], v[96:99], v[160:175]
    ds_read_b64_tr_b16 v[228:229], v212 offset:24576
    ds_read_b64_tr_b16 v[230:231], v212 offset:25600
    v_and_b32 v4, 1, v4
    v_lshl_add_u32 v4, v4, 9, v2
    v_cmp_gt_u32 vcc, 480, v0
    v_add3_u32 v4, v4, v6, s1
    s_waitcnt lgkmcnt(6)
    v_mfma_f32_32x32x16_bf16 v[176:191], v[196:199], v[96:99], v[176:191]
    ds_read_b64_tr_b16 v[232:233], v213 offset:24576
    ds_read_b64_tr_b16 v[234:235], v213 offset:25600
    s_add_u32 s1, s1, 245760
    v_cndmask_b32 v242, v5, v4, vcc
    s_lshr_b32 s32, s39, 1
    s_mul_i32 s32, s32, 5120
    s_waitcnt lgkmcnt(6)
    v_mfma_f32_32x32x16_bf16 v[160:175], v[200:203], v[100:103], v[160:175]
    ds_read_b64_tr_b16 v[192:193], v212 offset:28672
    ds_read_b64_tr_b16 v[194:195], v212 offset:29696
    s_and_b32 s33, s39, 1
    s_lshl_b32 s33, s33, 9
    s_add_u32 s32, s32, s33
    s_add_u32 s32, s32, s1
    s_waitcnt lgkmcnt(6)
    v_mfma_f32_32x32x16_bf16 v[176:191], v[204:207], v[100:103], v[176:191]
    ds_read_b64_tr_b16 v[196:197], v213 offset:28672
    ds_read_b64_tr_b16 v[198:199], v213 offset:29696
    v_add_u32 v2, s32, v2
    s_lshr_b32 s32, s39, 3
    s_mul_i32 s32, s32, 5120
    s_bfe_u32 s33, s39, 0x20001
    s_waitcnt lgkmcnt(6)
    v_mfma_f32_32x32x16_bf16 v[160:175], v[228:231], v[104:107], v[160:175]
    ds_read_b64_tr_b16 v[200:201], v214 offset:16384
    ds_read_b64_tr_b16 v[202:203], v214 offset:17408
    s_lshl_b32 s33, s33, 8
    s_add_u32 s32, s32, s33
    s_add_u32 s32, s32, 71680
    s_add_u32 s32, s32, s1
    s_waitcnt lgkmcnt(6)
    v_mfma_f32_32x32x16_bf16 v[176:191], v[232:235], v[104:107], v[176:191]
    ds_read_b64_tr_b16 v[204:205], v215 offset:16384
    ds_read_b64_tr_b16 v[206:207], v215 offset:17408
    v_lshrrev_b32 v1, 4, v0
    v_and_b32 v4, 0xff, v255
    v_lshl_add_u32 v4, v1, 10, v4
    v_add_u32 v4, s32, v4
    s_waitcnt lgkmcnt(6)
    v_mfma_f32_32x32x16_bf16 v[160:175], v[192:195], v[108:111], v[160:175]
    ds_read_b64_tr_b16 v[228:229], v214 offset:20480
    ds_read_b64_tr_b16 v[230:231], v214 offset:21504
    v_bfe_u32 v6, v236, 4, 1
    v_mul_u32_u24 v6, 640, v6
    v_sub_u32 v3, v3, v6
    v_lshl_add_u32 v3, v1, 5, v3
    s_waitcnt lgkmcnt(6)
    v_mfma_f32_32x32x16_bf16 v[176:191], v[196:199], v[108:111], v[176:191]
    ds_read_b64_tr_b16 v[232:233], v215 offset:20480
    ds_read_b64_tr_b16 v[234:235], v215 offset:21504
    v_cmp_gt_u32 vcc, 160, v0
    v_add_u32 v3, 153792, v3
    s_and_b32 s33, s39, 1
    s_mul_i32 s33, s33, 80
    s_waitcnt lgkmcnt(6)
    v_mfma_f32_32x32x16_bf16 v[160:175], v[200:203], v[112:115], v[160:175]
    ds_read_b64_tr_b16 v[192:193], v214 offset:24576
    ds_read_b64_tr_b16 v[194:195], v214 offset:25600
    s_sub_u32 s33, 240, s33
    v_cndmask_b32 v4, v4, v2, vcc
    v_cndmask_b32 v241, v3, v241, vcc
    v_cmp_gt_u32 vcc, s33, v0
    s_waitcnt lgkmcnt(6)
    v_mfma_f32_32x32x16_bf16 v[176:191], v[204:207], v[112:115], v[176:191]
    ds_read_b64_tr_b16 v[196:197], v215 offset:24576
    ds_read_b64_tr_b16 v[198:199], v215 offset:25600
    s_nop 1
    v_cndmask_b32 v243, v5, v4, vcc
    s_lshl_b32 s31, s40, 8
    s_add_u32 s31, s31, 16883712
    s_waitcnt lgkmcnt(6)
    v_mfma_f32_32x32x16_bf16 v[160:175], v[228:231], v[116:119], v[160:175]
    ds_read_b64_tr_b16 v[200:201], v214 offset:28672
    ds_read_b64_tr_b16 v[202:203], v214 offset:29696
    s_lshl_b32 s32, s39, 3
    s_add_u32 s32, s32, s31
    s_cmp_eq_u32 s24, 0
    s_cselect_b32 s100, s32, 0x80000000
    s_waitcnt lgkmcnt(6)
    v_mfma_f32_32x32x16_bf16 v[176:191], v[232:235], v[116:119], v[176:191]
    ds_read_b64_tr_b16 v[204:205], v215 offset:28672
    ds_read_b64_tr_b16 v[206:207], v215 offset:29696
    s_lshr_b32 s32, s39, 1
    s_lshl_b32 s32, s32, 7
    s_add_u32 s32, s32, 16818176
    s_lshr_b32 s33, s39, 2
    s_waitcnt lgkmcnt(6)
    v_mfma_f32_32x32x16_bf16 v[160:175], v[192:195], v[120:123], v[160:175]
    s_waitcnt vmcnt(2)
    s_barrier
    ds_read_b64_tr_b16 v[228:229], v212 offset:32768
    ds_read_b64_tr_b16 v[230:231], v212 offset:33792
    s_lshl_b32 s33, s33, 8
    s_add_u32 s33, s33, 16850944
    v_and_b32 v0, 15, v236
    v_and_b32 v1, 7, v236
    s_waitcnt lgkmcnt(6)
    v_mfma_f32_32x32x16_bf16 v[176:191], v[196:199], v[120:123], v[176:191]
    ds_read_b64_tr_b16 v[232:233], v213 offset:32768
    ds_read_b64_tr_b16 v[234:235], v213 offset:33792
    v_lshl_add_u32 v3, v0, 4, s33
    v_lshl_add_u32 v4, v1, 4, s32
    v_cmp_gt_u32 vcc, 16, v236
    v_lshl_add_u32 v0, v0, 4, s31
    s_waitcnt lgkmcnt(6)
    v_mfma_f32_32x32x16_bf16 v[160:175], v[200:203], v[124:127], v[160:175]
    ds_read_b64_tr_b16 v[192:193], v212 offset:36864
    ds_read_b64_tr_b16 v[194:195], v212 offset:37888
    s_nop 0
    v_cndmask_b32 v3, v4, v3, vcc
    v_cmp_gt_u32 vcc, 32, v236
    s_nop 1
    s_waitcnt lgkmcnt(6)
    v_mfma_f32_32x32x16_bf16 v[176:191], v[204:207], v[124:127], v[176:191]
    ds_read_b64_tr_b16 v[196:197], v213 offset:36864
    ds_read_b64_tr_b16 v[198:199], v213 offset:37888
    v_cndmask_b32 v251, v0, v3, vcc
    s_mul_i32 s31, s25, 81920
    s_lshl_b32 s32, s26, 1
    s_lshr_b32 s33, s28, 1
    s_waitcnt lgkmcnt(6)
    v_mfma_f32_32x32x16_bf16 v[160:175], v[228:231], v[128:131], v[160:175]
    ds_read_b64_tr_b16 v[200:201], v212 offset:40960
    ds_read_b64_tr_b16 v[202:203], v212 offset:41984
    s_add_u32 s32, s32, s33
    s_mul_i32 s32, s32, 5120
    s_add_u32 s31, s31, s32
    s_and_b32 s33, s28, 1
    s_waitcnt lgkmcnt(6)
    v_mfma_f32_32x32x16_bf16 v[176:191], v[232:235], v[128:131], v[176:191]
    ds_read_b64_tr_b16 v[204:205], v213 offset:40960
    ds_read_b64_tr_b16 v[206:207], v213 offset:41984
    s_lshl_b32 s32, s33, 11
    s_add_u32 s32, s32, s31
    s_lshl_b32 s33, s33, 9
    s_add_u32 s33, s33, s31
    s_waitcnt lgkmcnt(6)
    v_mfma_f32_32x32x16_bf16 v[160:175], v[192:195], v[132:135], v[160:175]
    ds_read_b64_tr_b16 v[228:229], v212 offset:45056
    ds_read_b64_tr_b16 v[230:231], v212 offset:46080
    s_add_u32 s33, s33, 4096
    s_lshl_b32 s31, s26, 3
    s_lshl_b32 s29, s28, 1
    s_add_u32 s29, s31, s29
    s_waitcnt lgkmcnt(6)
    v_mfma_f32_32x32x16_bf16 v[176:191], v[196:199], v[132:135], v[176:191]
    ds_read_b64_tr_b16 v[232:233], v213 offset:45056
    ds_read_b64_tr_b16 v[234:235], v213 offset:46080
    s_lshl_b32 s30, s29, 7
    s_lshl_b32 s31, s27, 6
    s_add_u32 s30, s30, s31
    s_add_u32 s30, s30, 16777216
    s_waitcnt lgkmcnt(6)
    v_mfma_f32_32x32x16_bf16 v[160:175], v[200:203], v[136:139], v[160:175]
    ds_read_b64_tr_b16 v[192:193], v214 offset:32768
    ds_read_b64_tr_b16 v[194:195], v214 offset:33792
    s_mul_i32 s36, s25, 163840
    s_add_u32 s36, s36, 2621440
    s_add_u32 s34, s36, s65
    s_mov_b32 s38, 0x000fffff
    s_waitcnt lgkmcnt(6)
    v_mfma_f32_32x32x16_bf16 v[176:191], v[204:207], v[136:139], v[176:191]
    ds_read_b64_tr_b16 v[196:197], v215 offset:32768
    ds_read_b64_tr_b16 v[198:199], v215 offset:33792
    s_mov_b32 s39, 0x000fffff
    s_mov_b64 s[20:21], s[50:51]
    s_mov_b32 s22, 2621440
    v_lshrrev_b32 v2, 5, v236
    s_waitcnt lgkmcnt(6)
    v_mfma_f32_32x32x16_bf16 v[160:175], v[228:231], v[140:143], v[160:175]
    ds_read_b64_tr_b16 v[200:201], v214 offset:36864
    ds_read_b64_tr_b16 v[202:203], v214 offset:37888
    v_add_u32 v252, s0, v255
    v_and_b32 v0, 31, v236
    v_mul_u32_u24 v3, 320, v2
    v_lshl_add_u32 v3, v0, 4, v3
    s_waitcnt lgkmcnt(6)
    v_mfma_f32_32x32x16_bf16 v[176:191], v[232:235], v[140:143], v[176:191]
    ds_read_b64_tr_b16 v[204:205], v215 offset:36864
    ds_read_b64_tr_b16 v[206:207], v215 offset:37888
    v_add_u32 v3, 5120, v3
    v_add_u32 v253, s0, v3
    v_and_b32 v0, 15, v236
    s_mul_i32 s31, s13, 5120
    s_waitcnt lgkmcnt(6)
    v_mfma_f32_32x32x16_bf16 v[160:175], v[192:195], v[144:147], v[160:175]
    ds_read_b64_tr_b16 v[228:229], v214 offset:40960
    ds_read_b64_tr_b16 v[230:231], v214 offset:41984
    s_add_u32 s31, s31, s0
    v_add_u32 v250, s31, v255
    v_lshrrev_b32 v3, 4, v236
    v_lshlrev_b32 v0, 4, v0
    s_waitcnt lgkmcnt(6)
    v_mfma_f32_32x32x16_bf16 v[176:191], v[196:199], v[144:147], v[176:191]
    ds_read_b64_tr_b16 v[232:233], v215 offset:40960
    ds_read_b64_tr_b16 v[234:235], v215 offset:41984
    v_lshl_add_u32 v249, v3, 9, v0
    s_lshl_b32 s31, s3, 8
    v_add_u32 v249, s31, v249
    v_add_u32 v248, 98304, v249
    s_waitcnt lgkmcnt(6)
    v_mfma_f32_32x32x16_bf16 v[160:175], v[200:203], v[148:151], v[160:175]
    ds_read_b64_tr_b16 v[192:193], v214 offset:45056
    ds_read_b64_tr_b16 v[194:195], v214 offset:46080
    s_waitcnt lgkmcnt(6)
    v_mfma_f32_32x32x16_bf16 v[176:191], v[204:207], v[148:151], v[176:191]
    ds_read_b64_tr_b16 v[196:197], v215 offset:45056
    ds_read_b64_tr_b16 v[198:199], v215 offset:46080
    s_waitcnt lgkmcnt(6)
    v_mfma_f32_32x32x16_bf16 v[160:175], v[228:231], v[152:155], v[160:175]
    v_mov_b32 v14, 139264
    s_waitcnt vmcnt(0)
    s_barrier
    ds_read_b32 v13, v14
    ds_read_b64_tr_b16 v[216:217], v240 offset:0
    ds_read_b64_tr_b16 v[218:219], v240 offset:1280
    ds_read_b64_tr_b16 v[244:245], v241 offset:0
    ds_read_b64_tr_b16 v[246:247], v241 offset:1280
    s_waitcnt lgkmcnt(9)
    v_mfma_f32_32x32x16_bf16 v[176:191], v[232:235], v[152:155], v[176:191]
    s_waitcnt lgkmcnt(7)
    v_mfma_f32_32x32x16_bf16 v[160:175], v[192:195], v[156:159], v[160:175]
    s_waitcnt lgkmcnt(4)
    v_readfirstlane_b32 s14, v13
    s_cmp_eq_u32 s14, 0
    s_cbranch_scc0 L_early2
    buffer_load_dwordx4 v[96:99], v255, s[16:19], s32 offen sc1
    buffer_load_dwordx4 v[100:103], v255, s[16:19], s32 offen offset:1024 sc1
    buffer_load_dwordx4 v[108:111], v12, s[16:19], s33 offen sc1
L_early2:
    s_waitcnt lgkmcnt(5)
    v_mfma_f32_32x32x16_bf16 v[176:191], v[196:199], v[156:159], v[176:191]
    s_cmp_eq_u32 s14, 0
    s_cbranch_scc0 L_late2
L_late2_ret:
    v_mov_b64 v[64:65], 0
    v_mov_b64 v[66:67], 0
    v_mov_b64 v[68:69], 0
    v_mov_b64 v[70:71], 0
    v_mov_b64 v[72:73], 0
    v_mov_b64 v[74:75], 0
    v_mov_b64 v[76:77], 0
    v_mov_b64 v[78:79], 0
    v_mov_b64 v[80:81], 0
    v_mov_b64 v[82:83], 0
    v_mov_b64 v[84:85], 0
    v_mov_b64 v[86:87], 0
    v_mov_b64 v[88:89], 0
    v_mov_b64 v[90:91], 0
    v_mov_b64 v[92:93], 0
    v_mov_b64 v[94:95], 0
    v_bfe_u32 v0, v255, 4, 5
    v_mov_b32 v1, 0x3f803f80
    v_cmp_eq_u32 s[40:41], 20, v0
    v_mov_b32 v122, 0xdddddddd
    v_lshrrev_b32 v2, 2, v12
    v_cndmask_b32 v112, 0, v1, s[40:41]
    v_cndmask_b32 v113, 0, v1, s[40:41]
    v_cndmask_b32 v114, 0, v1, s[40:41]
    v_cndmask_b32 v115, 0, v1, s[40:41]
    v_cndmask_b32 v116, 0, v1, s[40:41]
    v_cndmask_b32 v117, 0, v1, s[40:41]
    v_cndmask_b32 v118, 0, v1, s[40:41]
    v_cndmask_b32 v119, 0, v1, s[40:41]
    v_and_b32 v3, 64, v2
    v_add_u32 v123, v2, v3
    v_bfe_u32 v2, v255, 8, 1
    v_mul_u32_u24 v2, 32512, v2
    v_add_u32 v126, v2, v255
    v_mov_b64 v[236:237], -1
    v_mov_b64 v[238:239], -1
    v_cvt_pk_bf16_f32 v192, v160, v161
    v_cvt_pk_bf16_f32 v193, v162, v163
    v_cvt_pk_bf16_f32 v194, v164, v165
    v_cvt_pk_bf16_f32 v195, v166, v167
    v_pk_max_i16 v192, v192, 0
    v_pk_max_i16 v193, v193, 0
    v_pk_max_i16 v194, v194, 0
    v_pk_max_i16 v195, v195, 0
    v_cvt_pk_bf16_f32 v196, v168, v169
    v_cvt_pk_bf16_f32 v197, v170, v171
    v_cvt_pk_bf16_f32 v198, v172, v173
    v_cvt_pk_bf16_f32 v199, v174, v175
    v_pk_max_i16 v196, v196, 0
    v_pk_max_i16 v197, v197, 0
    v_pk_max_i16 v198, v198, 0
    v_pk_max_i16 v199, v199, 0
    v_cvt_pk_bf16_f32 v200, v176, v177
    v_cvt_pk_bf16_f32 v201, v178, v179
    v_cvt_pk_bf16_f32 v202, v180, v181
    v_cvt_pk_bf16_f32 v203, v182, v183
    v_pk_max_i16 v200, v200, 0
    v_pk_max_i16 v201, v201, 0
    v_pk_max_i16 v202, v202, 0
    v_pk_max_i16 v203, v203, 0
    v_cvt_pk_bf16_f32 v204, v184, v185
    v_cvt_pk_bf16_f32 v205, v186, v187
    v_cvt_pk_bf16_f32 v206, v188, v189
    v_cvt_pk_bf16_f32 v207, v190, v191
    v_pk_max_i16 v204, v204, 0
    v_pk_max_i16 v205, v205, 0
    v_pk_max_i16 v206, v206, 0
    v_pk_max_i16 v207, v207, 0
    v_mov_b32 v208, v255
    s_lshr_b32 s31, s24, 1
    s_xor_b32 s13, s31, 0
    s_lshl_b32 s13, s13, 10
    v_add_u32 v224, s13, v250
    v_add_u32 v229, 71680, v224
    s_xor_b32 s13, s31, 1
    s_lshl_b32 s13, s13, 10
    v_add_u32 v225, s13, v250
    v_add_u32 v230, 71680, v225
    s_xor_b32 s13, s31, 2
    s_lshl_b32 s13, s13, 10
    v_add_u32 v226, s13, v250
    v_add_u32 v231, 71680, v226
    s_xor_b32 s13, s31, 3
    s_lshl_b32 s13, s13, 10
    v_add_u32 v227, s13, v250
    v_add_u32 v232, 71680, v227
    v_add_u32 v228, 4096, v250
    v_add_u32 v233, 71680, v228
    s_lshl_b32 s31, s24, 6
    v_lshrrev_b32 v2, 4, v255
    v_add_u32 v2, s31, v2
    v_lshlrev_b32 v3, 7, v2
    s_mul_i32 s31, s26, 12800
    s_add_u32 s31, s31, s1
    v_cmp_gt_u32 vcc, 100, v2
    v_add_u32 v3, s31, v3
    v_mov_b32 v2, 0x80000000
    s_nop 0
    v_cndmask_b32 v234, v2, v3, vcc
L_p2_done:
    s_waitcnt vmcnt(0) lgkmcnt(0)
    v_mov_b32 v120, v108
    v_mov_b32 v121, v109
    s_mov_b32 exec_lo, 0
    v_mov_b32 v120, v110
    v_mov_b32 v121, v111
    s_mov_b64 exec, -1
    s_barrier
    ds_read_b128 v[108:111], v252 offset:4096
    ds_read_b128 v[104:107], v252 offset:0
    s_lshl_b32 s31, s29, 15
    s_lshl_b32 s32, s25, 10
    s_add_u32 s32, s32, s31
    s_lshl_b32 s13, s27, 8
    s_add_u32 s31, s13, 14155776
    s_add_u32 s32, s32, s31
    s_lshl_b32 s31, s29, 13
    s_lshl_b32 s33, s25, 9
    s_add_u32 s33, s33, s31
    s_add_u32 s31, s13, 16252928
    s_add_u32 s33, s33, s31
    s_waitcnt lgkmcnt(1)
    v_mfma_f32_32x32x4_2b_bf16 v[0:31], v[108:109], v[120:121], 0 cbsz:1 abid:0
    s_cmp_eq_u32 s27, 0
    s_cselect_b64 vcc, 0, -1
    s_add_u32 m0, s65, 10240
    s_add_u32 s34, s34, 10240
    buffer_load_dwordx4 v255, s[16:19], s34 offen offset:0 sc1 lds
    buffer_load_dwordx4 v255, s[16:19], s34 offen offset:1024 sc1 lds
    s_cbranch_vccnz L_pc1
    buffer_load_dwordx4 v255, s[16:19], s34 offen offset:2048 sc1 lds
L_pc1:
    s_waitcnt lgkmcnt(0)
    s_nop 7
    s_nop 2
    v_mfma_f32_32x32x16_bf16 v[0:15], v[104:107], v[96:99], v[0:15]
    v_mfma_f32_32x32x16_bf16 v[16:31], v[104:107], v[100:103], v[16:31]
    s_nop 7
    s_cbranch_vccz L_pr0
    s_setprio 1
L_pr0:
    ds_read_b128 v[104:107], v252 offset:1024
    s_add_u32 m0, s65, 20480
    s_add_u32 s34, s34, 10240
    buffer_load_dwordx4 v255, s[16:19], s34 offen offset:0 sc1 lds
    v_exp_f32 v0, v0
    v_exp_f32 v1, v1
    v_exp_f32 v2, v2
    v_exp_f32 v3, v3
    buffer_load_dwordx4 v255, s[16:19], s34 offen offset:1024 sc1 lds
    v_exp_f32 v4, v4
    v_exp_f32 v5, v5
    v_exp_f32 v6, v6
    v_exp_f32 v7, v7
    v_mfma_f32_32x32x4_2b_bf16 v[32:63], v[110:111], v[120:121], 0 cbsz:1 abid:0
    s_mov_b64 exec, s[38:39]
    ds_read_b128 v[112:115], v253 offset:0
    ds_read_b128 v[116:119], v253 offset:640
    s_mov_b64 exec, -1
    v_exp_f32 v8, v8
    v_exp_f32 v9, v9
    v_exp_f32 v10, v10
    v_exp_f32 v11, v11
    v_exp_f32 v12, v12
    v_exp_f32 v13, v13
    v_exp_f32 v14, v14
    v_exp_f32 v15, v15
    s_waitcnt lgkmcnt(0)
    v_smfmac_f32_32x32x32_bf16 v[64:79], v[112:115], v[0:7], v122
    v_exp_f32 v16, v16
    v_exp_f32 v17, v17
    v_exp_f32 v18, v18
    v_exp_f32 v19, v19
    v_mfma_f32_32x32x16_bf16 v[32:47], v[104:107], v[96:99], v[32:47]
    s_cbranch_vccnz L_pc2
    buffer_load_dwordx4 v255, s[16:19], s34 offen offset:2048 sc1 lds
L_pc2:
    v_exp_f32 v20, v20
    v_exp_f32 v21, v21
    v_exp_f32 v22, v22
    v_exp_f32 v23, v23
    v_smfmac_f32_32x32x32_bf16 v[64:79], v[116:119], v[8:15], v122
    s_add_u32 m0, s65, 30720
    s_add_u32 s34, s34, 10240
    buffer_load_dwordx4 v255, s[16:19], s34 offen offset:0 sc1 lds
    v_exp_f32 v24, v24
    v_exp_f32 v25, v25
    v_exp_f32 v26, v26
    v_exp_f32 v27, v27
    v_mfma_f32_32x32x16_bf16 v[48:63], v[104:107], v[100:103], v[48:63]
    v_exp_f32 v28, v28
    v_exp_f32 v29, v29
    v_exp_f32 v30, v30
    v_exp_f32 v31, v31
    v_smfmac_f32_32x32x32_bf16 v[80:95], v[112:115], v[16:23], v122
    ds_read_b128 v[104:107], v252 offset:2048
    buffer_load_dwordx4 v255, s[16:19], s34 offen offset:1024 sc1 lds
    v_exp_f32 v32, v32
    v_exp_f32 v33, v33
    v_exp_f32 v34, v34
    v_exp_f32 v35, v35
    v_smfmac_f32_32x32x32_bf16 v[80:95], v[116:119], v[24:31], v122
    s_cbranch_vccnz L_pc3
    buffer_load_dwordx4 v255, s[16:19], s34 offen offset:2048 sc1 lds
L_pc3:
    v_exp_f32 v36, v36
    v_exp_f32 v37, v37
    v_exp_f32 v38, v38
    v_exp_f32 v39, v39
    v_mfma_f32_32x32x4_2b_bf16 v[0:31], v[108:109], v[120:121], 0 cbsz:1 abid:1
    s_mov_b64 exec, s[38:39]
    ds_read_b128 v[112:115], v253 offset:1280
    ds_read_b128 v[116:119], v253 offset:1920
    s_mov_b64 exec, -1
    v_exp_f32 v40, v40
    v_exp_f32 v41, v41
    v_exp_f32 v42, v42
    v_exp_f32 v43, v43
    v_exp_f32 v44, v44
    v_exp_f32 v45, v45
    v_exp_f32 v46, v46
    v_exp_f32 v47, v47
    s_waitcnt lgkmcnt(0)
    v_smfmac_f32_32x32x32_bf16 v[64:79], v[112:115], v[32:39], v122
    v_exp_f32 v48, v48
    v_exp_f32 v49, v49
    v_exp_f32 v50, v50
    v_exp_f32 v51, v51
    v_mfma_f32_32x32x16_bf16 v[0:15], v[104:107], v[96:99], v[0:15]
    s_add_u32 m0, s65, 40960
    s_add_u32 s34, s34, 10240
    buffer_load_dwordx4 v255, s[16:19], s34 offen offset:0 sc1 lds
    v_exp_f32 v52, v52
    v_exp_f32 v53, v53
    v_exp_f32 v54, v54
    v_exp_f32 v55, v55
    v_smfmac_f32_32x32x32_bf16 v[64:79], v[116:119], v[40:47], v122
    buffer_load_dwordx4 v255, s[16:19], s34 offen offset:1024 sc1 lds
    v_exp_f32 v56, v56
    v_exp_f32 v57, v57
    v_exp_f32 v58, v58
    v_exp_f32 v59, v59
    v_mfma_f32_32x32x16_bf16 v[16:31], v[104:107], v[100:103], v[16:31]
    v_exp_f32 v60, v60
    v_exp_f32 v61, v61
    v_exp_f32 v62, v62
    v_exp_f32 v63, v63
    v_smfmac_f32_32x32x32_bf16 v[80:95], v[112:115], v[48:55], v122
    s_cbranch_vccz L_pr4
    s_setprio 0
L_pr4:
    ds_read_b128 v[104:107], v252 offset:3072
    s_cbranch_vccnz L_pc4
    buffer_load_dwordx4 v255, s[16:19], s34 offen offset:2048 sc1 lds
L_pc4:
    v_exp_f32 v0, v0
    v_exp_f32 v1, v1
    v_exp_f32 v2, v2
    v_exp_f32 v3, v3
    v_smfmac_f32_32x32x32_bf16 v[80:95], v[116:119], v[56:63], v122
    s_add_u32 m0, s65, 51200
    s_add_u32 s34, s34, 10240
    buffer_load_dwordx4 v255, s[16:19], s34 offen offset:0 sc1 lds
    v_exp_f32 v4, v4
    v_exp_f32 v5, v5
    v_exp_f32 v6, v6
    v_exp_f32 v7, v7
    v_mfma_f32_32x32x4_2b_bf16 v[32:63], v[110:111], v[120:121], 0 cbsz:1 abid:1
    s_mov_b64 exec, s[38:39]
    ds_read_b128 v[112:115], v253 offset:2560
    ds_read_b128 v[116:119], v253 offset:3200
    s_mov_b64 exec, -1
    v_exp_f32 v8, v8
    v_exp_f32 v9, v9
    v_exp_f32 v10, v10
    v_exp_f32 v11, v11
    v_exp_f32 v12, v12
    v_exp_f32 v13, v13
    v_exp_f32 v14, v14
    v_exp_f32 v15, v15
    s_waitcnt lgkmcnt(0)
    v_smfmac_f32_32x32x32_bf16 v[64:79], v[112:115], v[0:7], v122
    v_exp_f32 v16, v16
    v_exp_f32 v17, v17
    v_exp_f32 v18, v18
    v_exp_f32 v19, v19
    v_mfma_f32_32x32x16_bf16 v[32:47], v[104:107], v[96:99], v[32:47]
    buffer_load_dwordx4 v255, s[16:19], s34 offen offset:1024 sc1 lds
    v_exp_f32 v20, v20
    v_exp_f32 v21, v21
    v_exp_f32 v22, v22
    v_exp_f32 v23, v23
    v_smfmac_f32_32x32x32_bf16 v[64:79], v[116:119], v[8:15], v122
    s_cbranch_vccnz L_pc5
    buffer_load_dwordx4 v255, s[16:19], s34 offen offset:2048 sc1 lds
L_pc5:
    v_exp_f32 v24, v24
    v_exp_f32 v25, v25
    v_exp_f32 v26, v26
    v_exp_f32 v27, v27
    v_mfma_f32_32x32x16_bf16 v[48:63], v[104:107], v[100:103], v[48:63]
    v_exp_f32 v28, v28
    v_exp_f32 v29, v29
    v_exp_f32 v30, v30
    v_exp_f32 v31, v31
    v_smfmac_f32_32x32x32_bf16 v[80:95], v[112:115], v[16:23], v122
    s_waitcnt vmcnt(8)
    s_barrier
    s_cbranch_vccz L_pr6
    s_setprio 1
L_pr6:
    ds_read_b128 v[108:111], v252 offset:14336
    ds_read_b128 v[104:107], v252 offset:10240
    s_add_u32 m0, s65, 61440
    s_add_u32 s34, s34, 10240
    buffer_load_dwordx4 v255, s[16:19], s34 offen offset:0 sc1 lds
    v_exp_f32 v32, v32
    v_exp_f32 v33, v33
    v_exp_f32 v34, v34
    v_exp_f32 v35, v35
    v_smfmac_f32_32x32x32_bf16 v[80:95], v[116:119], v[24:31], v122
    buffer_load_dwordx4 v255, s[16:19], s34 offen offset:1024 sc1 lds
    v_exp_f32 v36, v36
    v_exp_f32 v37, v37
    v_exp_f32 v38, v38
    v_exp_f32 v39, v39
    s_waitcnt lgkmcnt(1)
    v_mfma_f32_32x32x4_2b_bf16 v[0:31], v[108:109], v[120:121], 0 cbsz:1 abid:0
    s_mov_b64 exec, s[38:39]
    ds_read_b128 v[112:115], v253 offset:3840
    ds_read_b128 v[116:119], v253 offset:4480
    s_mov_b64 exec, -1
    v_exp_f32 v40, v40
    v_exp_f32 v41, v41
    v_exp_f32 v42, v42
    v_exp_f32 v43, v43
    v_exp_f32 v44, v44
    v_exp_f32 v45, v45
    v_exp_f32 v46, v46
    v_exp_f32 v47, v47
    s_waitcnt lgkmcnt(0)
    v_smfmac_f32_32x32x32_bf16 v[64:79], v[112:115], v[32:39], v122
    v_exp_f32 v48, v48
    v_exp_f32 v49, v49
    v_exp_f32 v50, v50
    v_exp_f32 v51, v51
    v_mfma_f32_32x32x16_bf16 v[0:15], v[104:107], v[96:99], v[0:15]
    s_cbranch_vccnz L_pc6
    buffer_load_dwordx4 v255, s[16:19], s34 offen offset:2048 sc1 lds
L_pc6:
    v_exp_f32 v52, v52
    v_exp_f32 v53, v53
    v_exp_f32 v54, v54
    v_exp_f32 v55, v55
    v_smfmac_f32_32x32x32_bf16 v[64:79], v[116:119], v[40:47], v122
    s_add_u32 m0, s65, 71680
    s_add_u32 s34, s34, 10240
    buffer_load_dwordx4 v255, s[16:19], s34 offen offset:0 sc1 lds
    v_exp_f32 v56, v56
    v_exp_f32 v57, v57
    v_exp_f32 v58, v58
    v_exp_f32 v59, v59
    v_mfma_f32_32x32x16_bf16 v[16:31], v[104:107], v[100:103], v[16:31]
    v_exp_f32 v60, v60
    v_exp_f32 v61, v61
    v_exp_f32 v62, v62
    v_exp_f32 v63, v63
    v_smfmac_f32_32x32x32_bf16 v[80:95], v[112:115], v[48:55], v122
    ds_read_b128 v[104:107], v252 offset:11264
    buffer_load_dwordx4 v255, s[16:19], s34 offen offset:1024 sc1 lds
    v_exp_f32 v0, v0
    v_exp_f32 v1, v1
    v_exp_f32 v2, v2
    v_exp_f32 v3, v3
    v_smfmac_f32_32x32x32_bf16 v[80:95], v[116:119], v[56:63], v122
    s_cbranch_vccnz L_pc7
    buffer_load_dwordx4 v255, s[16:19], s34 offen offset:2048 sc1 lds
L_pc7:
    v_exp_f32 v4, v4
    v_exp_f32 v5, v5
    v_exp_f32 v6, v6
    v_exp_f32 v7, v7
    v_mfma_f32_32x32x4_2b_bf16 v[32:63], v[110:111], v[120:121], 0 cbsz:1 abid:0
    s_mov_b64 exec, s[38:39]
    ds_read_b128 v[112:115], v253 offset:10240
    ds_read_b128 v[116:119], v253 offset:10880
    s_mov_b64 exec, -1
    v_exp_f32 v8, v8
    v_exp_f32 v9, v9
    v_exp_f32 v10, v10
    v_exp_f32 v11, v11
    v_exp_f32 v12, v12
    v_exp_f32 v13, v13
    v_exp_f32 v14, v14
    v_exp_f32 v15, v15
    s_waitcnt lgkmcnt(0)
    v_smfmac_f32_32x32x32_bf16 v[64:79], v[112:115], v[0:7], v122
    v_exp_f32 v16, v16
    v_exp_f32 v17, v17
    v_exp_f32 v18, v18
    v_exp_f32 v19, v19
    v_mfma_f32_32x32x16_bf16 v[32:47], v[104:107], v[96:99], v[32:47]
    buffer_load_dword v123, v123, s[16:19], s30 offen sc1
    buffer_store_dwordx4 v[216:219], v242, s[16:19], 0 offen sc1
    v_exp_f32 v20, v20
    v_exp_f32 v21, v21
    v_exp_f32 v22, v22
    v_exp_f32 v23, v23
    v_smfmac_f32_32x32x32_bf16 v[64:79], v[116:119], v[8:15], v122
    buffer_store_dwordx4 v[244:247], v243, s[16:19], 0 offen sc1
    v_exp_f32 v24, v24
    v_exp_f32 v25, v25
    v_exp_f32 v26, v26
    v_exp_f32 v27, v27
    v_mfma_f32_32x32x16_bf16 v[48:63], v[104:107], v[100:103], v[48:63]
    v_exp_f32 v28, v28
    v_exp_f32 v29, v29
    v_exp_f32 v30, v30
    v_exp_f32 v31, v31
    v_smfmac_f32_32x32x32_bf16 v[80:95], v[112:115], v[16:23], v122
    ds_read_b128 v[104:107], v252 offset:12288
    buffer_store_dwordx4 v[192:195], v255, s[16:19], s43 offen offset:0 sc1
    v_exp_f32 v32, v32
    v_exp_f32 v33, v33
    v_exp_f32 v34, v34
    v_exp_f32 v35, v35
    v_smfmac_f32_32x32x32_bf16 v[80:95], v[116:119], v[24:31], v122
    v_exp_f32 v36, v36
    v_exp_f32 v37, v37
    v_exp_f32 v38, v38
    v_exp_f32 v39, v39
    v_mfma_f32_32x32x4_2b_bf16 v[0:31], v[108:109], v[120:121], 0 cbsz:1 abid:1
    s_mov_b64 exec, s[38:39]
    ds_read_b128 v[112:115], v253 offset:11520
    ds_read_b128 v[116:119], v253 offset:12160
    s_mov_b64 exec, -1
    v_exp_f32 v40, v40
    v_exp_f32 v41, v41
    v_exp_f32 v42, v42
    v_exp_f32 v43, v43
    v_exp_f32 v44, v44
    v_exp_f32 v45, v45
    v_exp_f32 v46, v46
    v_exp_f32 v47, v47
    s_waitcnt lgkmcnt(0)
    v_smfmac_f32_32x32x32_bf16 v[64:79], v[112:115], v[32:39], v122
    v_exp_f32 v48, v48
    v_exp_f32 v49, v49
    v_exp_f32 v50, v50
    v_exp_f32 v51, v51
    v_mfma_f32_32x32x16_bf16 v[0:15], v[104:107], v[96:99], v[0:15]
    buffer_store_dwordx4 v[196:199], v255, s[16:19], s43 offen offset:1024 sc1
    v_exp_f32 v52, v52
    v_exp_f32 v53, v53
    v_exp_f32 v54, v54
    v_exp_f32 v55, v55
    v_smfmac_f32_32x32x32_bf16 v[64:79], v[116:119], v[40:47], v122
    v_exp_f32 v56, v56
    v_exp_f32 v57, v57
    v_exp_f32 v58, v58
    v_exp_f32 v59, v59
    v_mfma_f32_32x32x16_bf16 v[16:31], v[104:107], v[100:103], v[16:31]
    v_exp_f32 v60, v60
    v_exp_f32 v61, v61
    v_exp_f32 v62, v62
    v_exp_f32 v63, v63
    v_smfmac_f32_32x32x32_bf16 v[80:95], v[112:115], v[48:55], v122
    s_cbranch_vccz L_pr12
    s_setprio 0
L_pr12:
    ds_read_b128 v[104:107], v252 offset:13312
    buffer_store_dwordx4 v[200:203], v208, s[16:19], s43 offen offset:2048 sc1
    v_exp_f32 v0, v0
    v_exp_f32 v1, v1
    v_exp_f32 v2, v2
    v_exp_f32 v3, v3
    v_smfmac_f32_32x32x32_bf16 v[80:95], v[116:119], v[56:63], v122
    v_exp_f32 v4, v4
    v_exp_f32 v5, v5
    v_exp_f32 v6, v6
    v_exp_f32 v7, v7
    v_mfma_f32_32x32x4_2b_bf16 v[32:63], v[110:111], v[120:121], 0 cbsz:1 abid:1
    s_mov_b64 exec, s[38:39]
    ds_read_b128 v[112:115], v253 offset:12800
    ds_read_b128 v[116:119], v253 offset:13440
    s_mov_b64 exec, -1
    v_exp_f32 v8, v8
    v_exp_f32 v9, v9
    v_exp_f32 v10, v10
    v_exp_f32 v11, v11
    v_exp_f32 v12, v12
    v_exp_f32 v13, v13
    v_exp_f32 v14, v14
    v_exp_f32 v15, v15
    s_waitcnt lgkmcnt(0)
    v_smfmac_f32_32x32x32_bf16 v[64:79], v[112:115], v[0:7], v122
    v_exp_f32 v16, v16
    v_exp_f32 v17, v17
    v_exp_f32 v18, v18
    v_exp_f32 v19, v19
    v_mfma_f32_32x32x16_bf16 v[32:47], v[104:107], v[96:99], v[32:47]
    buffer_store_dwordx4 v[204:207], v208, s[16:19], s43 offen offset:3072 sc1
    v_exp_f32 v20, v20
    v_exp_f32 v21, v21
    v_exp_f32 v22, v22
    v_exp_f32 v23, v23
    v_smfmac_f32_32x32x32_bf16 v[64:79], v[116:119], v[8:15], v122
    v_exp_f32 v24, v24
    v_exp_f32 v25, v25
    v_exp_f32 v26, v26
    v_exp_f32 v27, v27
    v_mfma_f32_32x32x16_bf16 v[48:63], v[104:107], v[100:103], v[48:63]
    v_exp_f32 v28, v28
    v_exp_f32 v29, v29
    v_exp_f32 v30, v30
    v_exp_f32 v31, v31
    v_smfmac_f32_32x32x32_bf16 v[80:95], v[112:115], v[16:23], v122
    s_waitcnt vmcnt(17)
    s_barrier
    s_cbranch_vccz L_pr14
    s_setprio 1
L_pr14:
    ds_read_b128 v[108:111], v252 offset:24576
    ds_read_b128 v[104:107], v252 offset:20480
    buffer_store_dwordx4 v[236:239], v126, s[16:19], s32 offen sc1
    v_exp_f32 v32, v32
    v_exp_f32 v33, v33
    v_exp_f32 v34, v34
    v_exp_f32 v35, v35
    v_smfmac_f32_32x32x32_bf16 v[80:95], v[116:119], v[24:31], v122
    v_exp_f32 v36, v36
    v_exp_f32 v37, v37
    v_exp_f32 v38, v38
    v_exp_f32 v39, v39
    s_waitcnt lgkmcnt(1)
    v_mfma_f32_32x32x4_2b_bf16 v[0:31], v[108:109], v[120:121], 0 cbsz:1 abid:0
    s_mov_b64 exec, s[38:39]
    ds_read_b128 v[112:115], v253 offset:14080
    ds_read_b128 v[116:119], v253 offset:14720
    s_mov_b64 exec, -1
    v_exp_f32 v40, v40
    v_exp_f32 v41, v41
    v_exp_f32 v42, v42
    v_exp_f32 v43, v43
    v_exp_f32 v44, v44
    v_exp_f32 v45, v45
    v_exp_f32 v46, v46
    v_exp_f32 v47, v47
    s_waitcnt lgkmcnt(0)
    v_smfmac_f32_32x32x32_bf16 v[64:79], v[112:115], v[32:39], v122
    v_exp_f32 v48, v48
    v_exp_f32 v49, v49
    v_exp_f32 v50, v50
    v_exp_f32 v51, v51
    v_mfma_f32_32x32x16_bf16 v[0:15], v[104:107], v[96:99], v[0:15]
    s_mov_b64 exec, 0xffff
    buffer_store_dwordx4 v[236:239], v255, s[16:19], s33 offen sc1
    s_mov_b64 exec, -1
    v_exp_f32 v52, v52
    v_exp_f32 v53, v53
    v_exp_f32 v54, v54
    v_exp_f32 v55, v55
    v_smfmac_f32_32x32x32_bf16 v[64:79], v[116:119], v[40:47], v122
    v_exp_f32 v56, v56
    v_exp_f32 v57, v57
    v_exp_f32 v58, v58
    v_exp_f32 v59, v59
    v_mfma_f32_32x32x16_bf16 v[16:31], v[104:107], v[100:103], v[16:31]
    v_exp_f32 v60, v60
    v_exp_f32 v61, v61
    v_exp_f32 v62, v62
    v_exp_f32 v63, v63
    v_smfmac_f32_32x32x32_bf16 v[80:95], v[112:115], v[48:55], v122
    ds_read_b128 v[104:107], v252 offset:21504
    v_exp_f32 v0, v0
    v_exp_f32 v1, v1
    v_exp_f32 v2, v2
    v_exp_f32 v3, v3
    v_smfmac_f32_32x32x32_bf16 v[80:95], v[116:119], v[56:63], v122
    v_exp_f32 v4, v4
    v_exp_f32 v5, v5
    v_exp_f32 v6, v6
    v_exp_f32 v7, v7
    v_mfma_f32_32x32x4_2b_bf16 v[32:63], v[110:111], v[120:121], 0 cbsz:1 abid:0
    s_mov_b64 exec, s[38:39]
    ds_read_b128 v[112:115], v253 offset:20480
    ds_read_b128 v[116:119], v253 offset:21120
    s_mov_b64 exec, -1
    v_exp_f32 v8, v8
    v_exp_f32 v9, v9
    v_exp_f32 v10, v10
    v_exp_f32 v11, v11
    v_exp_f32 v12, v12
    v_exp_f32 v13, v13
    v_exp_f32 v14, v14
    v_exp_f32 v15, v15
    s_waitcnt lgkmcnt(0)
    v_smfmac_f32_32x32x32_bf16 v[64:79], v[112:115], v[0:7], v122
    v_exp_f32 v16, v16
    v_exp_f32 v17, v17
    v_exp_f32 v18, v18
    v_exp_f32 v19, v19
    v_mfma_f32_32x32x16_bf16 v[32:47], v[104:107], v[96:99], v[32:47]
    v_exp_f32 v20, v20
    v_exp_f32 v21, v21
    v_exp_f32 v22, v22
    v_exp_f32 v23, v23
    v_smfmac_f32_32x32x32_bf16 v[64:79], v[116:119], v[8:15], v122
    v_exp_f32 v24, v24
    v_exp_f32 v25, v25
    v_exp_f32 v26, v26
    v_exp_f32 v27, v27
    v_mfma_f32_32x32x16_bf16 v[48:63], v[104:107], v[100:103], v[48:63]
    v_exp_f32 v28, v28
    v_exp_f32 v29, v29
    v_exp_f32 v30, v30
    v_exp_f32 v31, v31
    v_smfmac_f32_32x32x32_bf16 v[80:95], v[112:115], v[16:23], v122
    ds_read_b128 v[104:107], v252 offset:22528
    v_exp_f32 v32, v32
    v_exp_f32 v33, v33
    v_exp_f32 v34, v34
    v_exp_f32 v35, v35
    v_smfmac_f32_32x32x32_bf16 v[80:95], v[116:119], v[24:31], v122
    v_exp_f32 v36, v36
    v_exp_f32 v37, v37
    v_exp_f32 v38, v38
    v_exp_f32 v39, v39
    v_mfma_f32_32x32x4_2b_bf16 v[0:31], v[108:109], v[120:121], 0 cbsz:1 abid:1
    s_mov_b64 exec, s[38:39]
    ds_read_b128 v[112:115], v253 offset:21760
    ds_read_b128 v[116:119], v253 offset:22400
    s_mov_b64 exec, -1
    v_exp_f32 v40, v40
    v_exp_f32 v41, v41
    v_exp_f32 v42, v42
    v_exp_f32 v43, v43
    v_exp_f32 v44, v44
    v_exp_f32 v45, v45
    v_exp_f32 v46, v46
    v_exp_f32 v47, v47
    s_waitcnt lgkmcnt(0)
    v_smfmac_f32_32x32x32_bf16 v[64:79], v[112:115], v[32:39], v122
    v_exp_f32 v48, v48
    v_exp_f32 v49, v49
    v_exp_f32 v50, v50
    v_exp_f32 v51, v51
    v_mfma_f32_32x32x16_bf16 v[0:15], v[104:107], v[96:99], v[0:15]
    v_exp_f32 v52, v52
    v_exp_f32 v53, v53
    v_exp_f32 v54, v54
    v_exp_f32 v55, v55
    v_smfmac_f32_32x32x32_bf16 v[64:79], v[116:119], v[40:47], v122
    v_exp_f32 v56, v56
    v_exp_f32 v57, v57
    v_exp_f32 v58, v58
    v_exp_f32 v59, v59
    v_mfma_f32_32x32x16_bf16 v[16:31], v[104:107], v[100:103], v[16:31]
    v_exp_f32 v60, v60
    v_exp_f32 v61, v61
    v_exp_f32 v62, v62
    v_exp_f32 v63, v63
    v_smfmac_f32_32x32x32_bf16 v[80:95], v[112:115], v[48:55], v122
    s_cbranch_vccz L_pr20
    s_setprio 0
L_pr20:
    ds_read_b128 v[104:107], v252 offset:23552
    v_exp_f32 v0, v0
    v_exp_f32 v1, v1
    v_exp_f32 v2, v2
    v_exp_f32 v3, v3
    v_smfmac_f32_32x32x32_bf16 v[80:95], v[116:119], v[56:63], v122
    v_exp_f32 v4, v4
    v_exp_f32 v5, v5
    v_exp_f32 v6, v6
    v_exp_f32 v7, v7
    v_mfma_f32_32x32x4_2b_bf16 v[32:63], v[110:111], v[120:121], 0 cbsz:1 abid:1
    s_mov_b64 exec, s[38:39]
    ds_read_b128 v[112:115], v253 offset:23040
    ds_read_b128 v[116:119], v253 offset:23680
    s_mov_b64 exec, -1
    v_exp_f32 v8, v8
    v_exp_f32 v9, v9
    v_exp_f32 v10, v10
    v_exp_f32 v11, v11
    v_exp_f32 v12, v12
    v_exp_f32 v13, v13
    v_exp_f32 v14, v14
    v_exp_f32 v15, v15
    s_waitcnt lgkmcnt(0)
    v_smfmac_f32_32x32x32_bf16 v[64:79], v[112:115], v[0:7], v122
    v_exp_f32 v16, v16
    v_exp_f32 v17, v17
    v_exp_f32 v18, v18
    v_exp_f32 v19, v19
    v_mfma_f32_32x32x16_bf16 v[32:47], v[104:107], v[96:99], v[32:47]
    v_exp_f32 v20, v20
    v_exp_f32 v21, v21
    v_exp_f32 v22, v22
    v_exp_f32 v23, v23
    v_smfmac_f32_32x32x32_bf16 v[64:79], v[116:119], v[8:15], v122
    v_exp_f32 v24, v24
    v_exp_f32 v25, v25
    v_exp_f32 v26, v26
    v_exp_f32 v27, v27
    v_mfma_f32_32x32x16_bf16 v[48:63], v[104:107], v[100:103], v[48:63]
    v_exp_f32 v28, v28
    v_exp_f32 v29, v29
    v_exp_f32 v30, v30
    v_exp_f32 v31, v31
    v_smfmac_f32_32x32x32_bf16 v[80:95], v[112:115], v[16:23], v122
    s_waitcnt vmcnt(0)
    s_barrier
    s_cbranch_vccz L_pr22
    s_setprio 1
L_pr22:
    ds_read_b128 v[108:111], v252 offset:34816
    ds_read_b128 v[104:107], v252 offset:30720
    v_mov_b32 v134, s66
    v_mov_b32 v132, s44
    v_mov_b32 v133, s45
    v_writelane_b32 v134, s67, 1
    v_writelane_b32 v134, s100, 2
    s_mov_b64 exec, 7
    buffer_store_dwordx2 v[132:133], v134, s[16:19], 0 offen sc1
    s_mov_b64 exec, -1
    v_exp_f32 v32, v32
    v_exp_f32 v33, v33
    v_exp_f32 v34, v34
    v_exp_f32 v35, v35
    v_smfmac_f32_32x32x32_bf16 v[80:95], v[116:119], v[24:31], v122
    v_exp_f32 v36, v36
    v_exp_f32 v37, v37
    v_exp_f32 v38, v38
    v_exp_f32 v39, v39
    s_waitcnt lgkmcnt(1)
    v_mfma_f32_32x32x4_2b_bf16 v[0:31], v[108:109], v[120:121], 0 cbsz:1 abid:0
    s_mov_b64 exec, s[38:39]
    ds_read_b128 v[112:115], v253 offset:24320
    ds_read_b128 v[116:119], v253 offset:24960
    s_mov_b64 exec, -1
    v_exp_f32 v40, v40
    v_exp_f32 v41, v41
    v_exp_f32 v42, v42
    v_exp_f32 v43, v43
    v_exp_f32 v44, v44
    v_exp_f32 v45, v45
    v_exp_f32 v46, v46
    v_exp_f32 v47, v47
    s_waitcnt lgkmcnt(0)
    v_smfmac_f32_32x32x32_bf16 v[64:79], v[112:115], v[32:39], v122
    v_exp_f32 v48, v48
    v_exp_f32 v49, v49
    v_exp_f32 v50, v50
    v_exp_f32 v51, v51
    v_mfma_f32_32x32x16_bf16 v[0:15], v[104:107], v[96:99], v[0:15]
    v_exp_f32 v52, v52
    v_exp_f32 v53, v53
    v_exp_f32 v54, v54
    v_exp_f32 v55, v55
    v_smfmac_f32_32x32x32_bf16 v[64:79], v[116:119], v[40:47], v122
    v_exp_f32 v56, v56
    v_exp_f32 v57, v57
    v_exp_f32 v58, v58
    v_exp_f32 v59, v59
    v_mfma_f32_32x32x16_bf16 v[16:31], v[104:107], v[100:103], v[16:31]
    v_exp_f32 v60, v60
    v_exp_f32 v61, v61
    v_exp_f32 v62, v62
    v_exp_f32 v63, v63
    v_smfmac_f32_32x32x32_bf16 v[80:95], v[112:115], v[48:55], v122
    ds_read_b128 v[104:107], v252 offset:31744
    v_exp_f32 v0, v0
    v_exp_f32 v1, v1
    v_exp_f32 v2, v2
    v_exp_f32 v3, v3
    v_smfmac_f32_32x32x32_bf16 v[80:95], v[116:119], v[56:63], v122
    v_exp_f32 v4, v4
    v_exp_f32 v5, v5
    v_exp_f32 v6, v6
    v_exp_f32 v7, v7
    v_mfma_f32_32x32x4_2b_bf16 v[32:63], v[110:111], v[120:121], 0 cbsz:1 abid:0
    s_mov_b64 exec, s[38:39]
    ds_read_b128 v[112:115], v253 offset:30720
    ds_read_b128 v[116:119], v253 offset:31360
    s_mov_b64 exec, -1
    v_exp_f32 v8, v8
    v_exp_f32 v9, v9
    v_exp_f32 v10, v10
    v_exp_f32 v11, v11
    v_exp_f32 v12, v12
    v_exp_f32 v13, v13
    v_exp_f32 v14, v14
    v_exp_f32 v15, v15
    s_waitcnt lgkmcnt(0)
    v_smfmac_f32_32x32x32_bf16 v[64:79], v[112:115], v[0:7], v122
    v_exp_f32 v16, v16
    v_exp_f32 v17, v17
    v_exp_f32 v18, v18
    v_exp_f32 v19, v19
    v_mfma_f32_32x32x16_bf16 v[32:47], v[104:107], v[96:99], v[32:47]
    v_exp_f32 v20, v20
    v_exp_f32 v21, v21
    v_exp_f32 v22, v22
    v_exp_f32 v23, v23
    v_smfmac_f32_32x32x32_bf16 v[64:79], v[116:119], v[8:15], v122
    v_exp_f32 v24, v24
    v_exp_f32 v25, v25
    v_exp_f32 v26, v26
    v_exp_f32 v27, v27
    v_mfma_f32_32x32x16_bf16 v[48:63], v[104:107], v[100:103], v[48:63]
    v_exp_f32 v28, v28
    v_exp_f32 v29, v29
    v_exp_f32 v30, v30
    v_exp_f32 v31, v31
    v_smfmac_f32_32x32x32_bf16 v[80:95], v[112:115], v[16:23], v122
    ds_read_b128 v[104:107], v252 offset:32768
    v_exp_f32 v32, v32
    v_exp_f32 v33, v33
    v_exp_f32 v34, v34
    v_exp_f32 v35, v35
    v_smfmac_f32_32x32x32_bf16 v[80:95], v[116:119], v[24:31], v122
    v_exp_f32 v36, v36
    v_exp_f32 v37, v37
    v_exp_f32 v38, v38
    v_exp_f32 v39, v39
    v_mfma_f32_32x32x4_2b_bf16 v[0:31], v[108:109], v[120:121], 0 cbsz:1 abid:1
    s_mov_b64 exec, s[38:39]
    ds_read_b128 v[112:115], v253 offset:32000
    ds_read_b128 v[116:119], v253 offset:32640
    s_mov_b64 exec, -1
    v_exp_f32 v40, v40
    v_exp_f32 v41, v41
    v_exp_f32 v42, v42
    v_exp_f32 v43, v43
    v_exp_f32 v44, v44
    v_exp_f32 v45, v45
    v_exp_f32 v46, v46
    v_exp_f32 v47, v47
    s_waitcnt lgkmcnt(0)
    v_smfmac_f32_32x32x32_bf16 v[64:79], v[112:115], v[32:39], v122
    v_exp_f32 v48, v48
    v_exp_f32 v49, v49
    v_exp_f32 v50, v50
    v_exp_f32 v51, v51
    v_mfma_f32_32x32x16_bf16 v[0:15], v[104:107], v[96:99], v[0:15]
    v_exp_f32 v52, v52
    v_exp_f32 v53, v53
    v_exp_f32 v54, v54
    v_exp_f32 v55, v55
    v_smfmac_f32_32x32x32_bf16 v[64:79], v[116:119], v[40:47], v122
    v_exp_f32 v56, v56
    v_exp_f32 v57, v57
    v_exp_f32 v58, v58
    v_exp_f32 v59, v59
    v_mfma_f32_32x32x16_bf16 v[16:31], v[104:107], v[100:103], v[16:31]
    v_exp_f32 v60, v60
    v_exp_f32 v61, v61
    v_exp_f32 v62, v62
    v_exp_f32 v63, v63
    v_smfmac_f32_32x32x32_bf16 v[80:95], v[112:115], v[48:55], v122
    ds_read_b128 v[104:107], v252 offset:33792
    v_exp_f32 v0, v0
    v_exp_f32 v1, v1
    v_exp_f32 v2, v2
    v_exp_f32 v3, v3
    v_smfmac_f32_32x32x32_bf16 v[80:95], v[116:119], v[56:63], v122
    v_exp_f32 v4, v4
    v_exp_f32 v5, v5
    v_exp_f32 v6, v6
    v_exp_f32 v7, v7
    v_mfma_f32_32x32x4_2b_bf16 v[32:63], v[110:111], v[120:121], 0 cbsz:1 abid:1
    s_mov_b64 exec, s[38:39]
    ds_read_b128 v[112:115], v253 offset:33280
    ds_read_b128 v[116:119], v253 offset:33920
    s_mov_b64 exec, -1
    v_exp_f32 v8, v8
    v_exp_f32 v9, v9
    v_exp_f32 v10, v10
    v_exp_f32 v11, v11
    v_exp_f32 v12, v12
    v_exp_f32 v13, v13
    v_exp_f32 v14, v14
    v_exp_f32 v15, v15
    s_waitcnt lgkmcnt(0)
    v_smfmac_f32_32x32x32_bf16 v[64:79], v[112:115], v[0:7], v122
    v_exp_f32 v16, v16
    v_exp_f32 v17, v17
    v_exp_f32 v18, v18
    v_exp_f32 v19, v19
    v_mfma_f32_32x32x16_bf16 v[32:47], v[104:107], v[96:99], v[32:47]
    v_exp_f32 v20, v20
    v_exp_f32 v21, v21
    v_exp_f32 v22, v22
    v_exp_f32 v23, v23
    v_smfmac_f32_32x32x32_bf16 v[64:79], v[116:119], v[8:15], v122
    v_exp_f32 v24, v24
    v_exp_f32 v25, v25
    v_exp_f32 v26, v26
    v_exp_f32 v27, v27
    v_mfma_f32_32x32x16_bf16 v[48:63], v[104:107], v[100:103], v[48:63]
    v_exp_f32 v28, v28
    v_exp_f32 v29, v29
    v_exp_f32 v30, v30
    v_exp_f32 v31, v31
    v_smfmac_f32_32x32x32_bf16 v[80:95], v[112:115], v[16:23], v122
    ds_read_b128 v[108:111], v252 offset:45056
    ds_read_b128 v[104:107], v252 offset:40960
    v_exp_f32 v32, v32
    v_exp_f32 v33, v33
    v_exp_f32 v34, v34
    v_exp_f32 v35, v35
    v_smfmac_f32_32x32x32_bf16 v[80:95], v[116:119], v[24:31], v122
    v_exp_f32 v36, v36
    v_exp_f32 v37, v37
    v_exp_f32 v38, v38
    v_exp_f32 v39, v39
    s_waitcnt lgkmcnt(1)
    v_mfma_f32_32x32x4_2b_bf16 v[0:31], v[108:109], v[120:121], 0 cbsz:1 abid:0
    s_mov_b64 exec, s[38:39]
    ds_read_b128 v[112:115], v253 offset:34560
    ds_read_b128 v[116:119], v253 offset:35200
    s_mov_b64 exec, -1
    v_exp_f32 v40, v40
    v_exp_f32 v41, v41
    v_exp_f32 v42, v42
    v_exp_f32 v43, v43
    v_exp_f32 v44, v44
    v_exp_f32 v45, v45
    v_exp_f32 v46, v46
    v_exp_f32 v47, v47
    s_waitcnt lgkmcnt(0)
    v_smfmac_f32_32x32x32_bf16 v[64:79], v[112:115], v[32:39], v122
    v_exp_f32 v48, v48
    v_exp_f32 v49, v49
    v_exp_f32 v50, v50
    v_exp_f32 v51, v51
    v_mfma_f32_32x32x16_bf16 v[0:15], v[104:107], v[96:99], v[0:15]
    buffer_load_dwordx4 v[128:131], v251, s[16:19], 0 offen sc1
    v_exp_f32 v52, v52
    v_exp_f32 v53, v53
    v_exp_f32 v54, v54
    v_exp_f32 v55, v55
    v_smfmac_f32_32x32x32_bf16 v[64:79], v[116:119], v[40:47], v122
    v_exp_f32 v56, v56
    v_exp_f32 v57, v57
    v_exp_f32 v58, v58
    v_exp_f32 v59, v59
    v_mfma_f32_32x32x16_bf16 v[16:31], v[104:107], v[100:103], v[16:31]
    v_exp_f32 v60, v60
    v_exp_f32 v61, v61
    v_exp_f32 v62, v62
    v_exp_f32 v63, v63
    v_smfmac_f32_32x32x32_bf16 v[80:95], v[112:115], v[48:55], v122
    v_add_u32 v252, 40960, v252
    v_add_u32 v253, 40960, v253
    ds_read_b128 v[104:107], v252 offset:1024
    v_exp_f32 v0, v0
    v_exp_f32 v1, v1
    v_exp_f32 v2, v2
    v_exp_f32 v3, v3
    v_smfmac_f32_32x32x32_bf16 v[80:95], v[116:119], v[56:63], v122
    v_exp_f32 v4, v4
    v_exp_f32 v5, v5
    v_exp_f32 v6, v6
    v_exp_f32 v7, v7
    v_mfma_f32_32x32x4_2b_bf16 v[32:63], v[110:111], v[120:121], 0 cbsz:1 abid:0
    s_mov_b64 exec, s[38:39]
    ds_read_b128 v[112:115], v253 offset:0
    ds_read_b128 v[116:119], v253 offset:640
    s_mov_b64 exec, -1
    v_exp_f32 v8, v8
    v_exp_f32 v9, v9
    v_exp_f32 v10, v10
    v_exp_f32 v11, v11
    v_exp_f32 v12, v12
    v_exp_f32 v13, v13
    v_exp_f32 v14, v14
    v_exp_f32 v15, v15
    s_waitcnt lgkmcnt(0)
    v_smfmac_f32_32x32x32_bf16 v[64:79], v[112:115], v[0:7], v122
    v_exp_f32 v16, v16
    v_exp_f32 v17, v17
    v_exp_f32 v18, v18
    v_exp_f32 v19, v19
    v_mfma_f32_32x32x16_bf16 v[32:47], v[104:107], v[96:99], v[32:47]
    v_exp_f32 v20, v20
    v_exp_f32 v21, v21
    v_exp_f32 v22, v22
    v_exp_f32 v23, v23
    v_smfmac_f32_32x32x32_bf16 v[64:79], v[116:119], v[8:15], v122
    v_exp_f32 v24, v24
    v_exp_f32 v25, v25
    v_exp_f32 v26, v26
    v_exp_f32 v27, v27
    v_mfma_f32_32x32x16_bf16 v[48:63], v[104:107], v[100:103], v[48:63]
    v_exp_f32 v28, v28
    v_exp_f32 v29, v29
    v_exp_f32 v30, v30
    v_exp_f32 v31, v31
    v_smfmac_f32_32x32x32_bf16 v[80:95], v[112:115], v[16:23], v122
    s_waitcnt vmcnt(0)
    v_cmp_ne_u64 vcc, s[44:45], v[128:129]
    v_cmp_ne_u64 s[40:41], s[44:45], v[130:131]
    s_nop 0
    s_or_b64 vcc, vcc, s[40:41]
    s_cbranch_vccnz L_w2
L_w2_ret:
    s_cmp_eq_u32 s27, 0
    s_cselect_b64 vcc, 0, -1
    ds_read_b128 v[104:107], v252 offset:2048
    v_bfe_u32 v124, v255, 4, 4
    v_lshlrev_b32 v124, 2, v124
    buffer_load_dword v125, v124, s[16:19], s64 offen offset:128 sc1
    buffer_load_dword v124, v124, s[16:19], s64 offen sc1
    v_exp_f32 v32, v32
    v_exp_f32 v33, v33
    v_exp_f32 v34, v34
    v_exp_f32 v35, v35
    v_smfmac_f32_32x32x32_bf16 v[80:95], v[116:119], v[24:31], v122
    v_exp_f32 v36, v36
    v_exp_f32 v37, v37
    v_exp_f32 v38, v38
    v_exp_f32 v39, v39
    v_mfma_f32_32x32x4_2b_bf16 v[0:31], v[108:109], v[120:121], 0 cbsz:1 abid:1
    s_mov_b64 exec, s[38:39]
    ds_read_b128 v[112:115], v253 offset:1280
    ds_read_b128 v[116:119], v253 offset:1920
    s_mov_b64 exec, -1
    v_exp_f32 v40, v40
    v_exp_f32 v41, v41
    v_exp_f32 v42, v42
    v_exp_f32 v43, v43
    v_exp_f32 v44, v44
    v_exp_f32 v45, v45
    v_exp_f32 v46, v46
    v_exp_f32 v47, v47
    s_waitcnt lgkmcnt(0)
    v_smfmac_f32_32x32x32_bf16 v[64:79], v[112:115], v[32:39], v122
    v_exp_f32 v48, v48
    v_exp_f32 v49, v49
    v_exp_f32 v50, v50
    v_exp_f32 v51, v51
    v_mfma_f32_32x32x16_bf16 v[0:15], v[104:107], v[96:99], v[0:15]
    s_add_u32 m0, s65, 0
    s_nop 0
    buffer_load_dwordx4 v255, s[16:19], s56 offen offset:0 sc1 lds
    v_exp_f32 v52, v52
    v_exp_f32 v53, v53
    v_exp_f32 v54, v54
    v_exp_f32 v55, v55
    v_smfmac_f32_32x32x32_bf16 v[64:79], v[116:119], v[40:47], v122
    buffer_load_dwordx4 v255, s[16:19], s56 offen offset:1024 sc1 lds
    v_exp_f32 v56, v56
    v_exp_f32 v57, v57
    v_exp_f32 v58, v58
    v_exp_f32 v59, v59
    v_mfma_f32_32x32x16_bf16 v[16:31], v[104:107], v[100:103], v[16:31]
    v_exp_f32 v60, v60
    v_exp_f32 v61, v61
    v_exp_f32 v62, v62
    v_exp_f32 v63, v63
    v_smfmac_f32_32x32x32_bf16 v[80:95], v[112:115], v[48:55], v122
    ds_read_b128 v[104:107], v252 offset:3072
    s_cbranch_vccnz L_pc8
    buffer_load_dwordx4 v255, s[16:19], s56 offen offset:2048 sc1 lds
L_pc8:
    s_add_u32 s56, s56, 20480
    s_cmp_eq_u32 s56, s61
    s_cselect_b32 s56, s60, s56
    v_exp_f32 v0, v0
    v_exp_f32 v1, v1
    v_exp_f32 v2, v2
    v_exp_f32 v3, v3
    v_smfmac_f32_32x32x32_bf16 v[80:95], v[116:119], v[56:63], v122
    s_add_u32 m0, s65, 10240
    s_nop 0
    buffer_load_dwordx4 v255, s[16:19], s56 offen offset:0 sc1 lds
    v_exp_f32 v4, v4
    v_exp_f32 v5, v5
    v_exp_f32 v6, v6
    v_exp_f32 v7, v7
    v_mfma_f32_32x32x4_2b_bf16 v[32:63], v[110:111], v[120:121], 0 cbsz:1 abid:1
    s_mov_b64 exec, s[38:39]
    ds_read_b128 v[112:115], v253 offset:2560
    ds_read_b128 v[116:119], v253 offset:3200
    s_mov_b64 exec, -1
    v_exp_f32 v8, v8
    v_exp_f32 v9, v9
    v_exp_f32 v10, v10
    v_exp_f32 v11, v11
    v_exp_f32 v12, v12
    v_exp_f32 v13, v13
    v_exp_f32 v14, v14
    v_exp_f32 v15, v15
    s_waitcnt lgkmcnt(0)
    v_smfmac_f32_32x32x32_bf16 v[64:79], v[112:115], v[0:7], v122
    v_exp_f32 v16, v16
    v_exp_f32 v17, v17
    v_exp_f32 v18, v18
    v_exp_f32 v19, v19
    v_mfma_f32_32x32x16_bf16 v[32:47], v[104:107], v[96:99], v[32:47]
    buffer_load_dwordx4 v255, s[16:19], s56 offen offset:1024 sc1 lds
    v_exp_f32 v20, v20
    v_exp_f32 v21, v21
    v_exp_f32 v22, v22
    v_exp_f32 v23, v23
    v_smfmac_f32_32x32x32_bf16 v[64:79], v[116:119], v[8:15], v122
    s_cbranch_vccnz L_pc9
    buffer_load_dwordx4 v255, s[16:19], s56 offen offset:2048 sc1 lds
L_pc9:
    s_add_u32 s56, s56, 20480
    s_cmp_eq_u32 s56, s61
    s_cselect_b32 s56, s60, s56
    v_exp_f32 v24, v24
    v_exp_f32 v25, v25
    v_exp_f32 v26, v26
    v_exp_f32 v27, v27
    v_mfma_f32_32x32x16_bf16 v[48:63], v[104:107], v[100:103], v[48:63]
    v_exp_f32 v28, v28
    v_exp_f32 v29, v29
    v_exp_f32 v30, v30
    v_exp_f32 v31, v31
    v_smfmac_f32_32x32x32_bf16 v[80:95], v[112:115], v[16:23], v122
    ds_read_b128 v[108:111], v252 offset:14336
    ds_read_b128 v[104:107], v252 offset:10240
    buffer_load_dword v234, v234, s[16:19], 0 offen sc1
    v_exp_f32 v32, v32
    v_exp_f32 v33, v33
    v_exp_f32 v34, v34
    v_exp_f32 v35, v35
    v_smfmac_f32_32x32x32_bf16 v[80:95], v[116:119], v[24:31], v122
    buffer_load_dwordx4 v[128:131], v249, s[16:19], s57 offen offset:0 sc1
    v_exp_f32 v36, v36
    v_exp_f32 v37, v37
    v_exp_f32 v38, v38
    v_exp_f32 v39, v39
    s_waitcnt lgkmcnt(1)
    v_mfma_f32_32x32x4_2b_bf16 v[0:31], v[108:109], v[120:121], 0 cbsz:1 abid:0
    s_mov_b64 exec, s[38:39]
    ds_read_b128 v[112:115], v253 offset:3840
    ds_read_b128 v[116:119], v253 offset:4480
    s_mov_b64 exec, -1
    v_exp_f32 v40, v40
    v_exp_f32 v41, v41
    v_exp_f32 v42, v42
    v_exp_f32 v43, v43
    v_exp_f32 v44, v44
    v_exp_f32 v45, v45
    v_exp_f32 v46, v46
    v_exp_f32 v47, v47
    s_waitcnt lgkmcnt(0)
    v_smfmac_f32_32x32x32_bf16 v[64:79], v[112:115], v[32:39], v122
    v_exp_f32 v48, v48
    v_exp_f32 v49, v49
    v_exp_f32 v50, v50
    v_exp_f32 v51, v51
    v_mfma_f32_32x32x16_bf16 v[0:15], v[104:107], v[96:99], v[0:15]
    buffer_load_dwordx4 v[132:135], v248, s[16:19], s57 offen offset:0 sc1
    s_add_u32 s57, s57, 8192
    s_cmp_eq_u32 s57, s62
    s_cselect_b32 s57, s58, s57
    v_exp_f32 v52, v52
    v_exp_f32 v53, v53
    v_exp_f32 v54, v54
    v_exp_f32 v55, v55
    v_smfmac_f32_32x32x32_bf16 v[64:79], v[116:119], v[40:47], v122
    v_exp_f32 v56, v56
    v_exp_f32 v57, v57
    v_exp_f32 v58, v58
    v_exp_f32 v59, v59
    v_mfma_f32_32x32x16_bf16 v[16:31], v[104:107], v[100:103], v[16:31]
    v_exp_f32 v60, v60
    v_exp_f32 v61, v61
    v_exp_f32 v62, v62
    v_exp_f32 v63, v63
    v_smfmac_f32_32x32x32_bf16 v[80:95], v[112:115], v[48:55], v122
    ds_read_b128 v[104:107], v252 offset:11264
    buffer_load_dwordx4 v[136:139], v249, s[16:19], s57 offen offset:0 sc1
    v_exp_f32 v0, v0
    v_exp_f32 v1, v1
    v_exp_f32 v2, v2
    v_exp_f32 v3, v3
    v_smfmac_f32_32x32x32_bf16 v[80:95], v[116:119], v[56:63], v122
    buffer_load_dwordx4 v[140:143], v248, s[16:19], s57 offen offset:0 sc1
    s_add_u32 s57, s57, 8192
    s_cmp_eq_u32 s57, s62
    s_cselect_b32 s57, s58, s57
    v_exp_f32 v4, v4
    v_exp_f32 v5, v5
    v_exp_f32 v6, v6
    v_exp_f32 v7, v7
    v_mfma_f32_32x32x4_2b_bf16 v[32:63], v[110:111], v[120:121], 0 cbsz:1 abid:0
    s_mov_b64 exec, s[38:39]
    ds_read_b128 v[112:115], v253 offset:10240
    ds_read_b128 v[116:119], v253 offset:10880
    s_mov_b64 exec, -1
    v_exp_f32 v8, v8
    v_exp_f32 v9, v9
    v_exp_f32 v10, v10
    v_exp_f32 v11, v11
    v_exp_f32 v12, v12
    v_exp_f32 v13, v13
    v_exp_f32 v14, v14
    v_exp_f32 v15, v15
    s_waitcnt lgkmcnt(0)
    v_smfmac_f32_32x32x32_bf16 v[64:79], v[112:115], v[0:7], v122
    v_exp_f32 v16, v16
    v_exp_f32 v17, v17
    v_exp_f32 v18, v18
    v_exp_f32 v19, v19
    v_mfma_f32_32x32x16_bf16 v[32:47], v[104:107], v[96:99], v[32:47]
    buffer_load_dwordx4 v[144:147], v249, s[16:19], s57 offen offset:0 sc1
    v_exp_f32 v20, v20
    v_exp_f32 v21, v21
    v_exp_f32 v22, v22
    v_exp_f32 v23, v23
    v_smfmac_f32_32x32x32_bf16 v[64:79], v[116:119], v[8:15], v122
    buffer_load_dwordx4 v[148:151], v248, s[16:19], s57 offen offset:0 sc1
    s_add_u32 s57, s57, 8192
    s_cmp_eq_u32 s57, s62
    s_cselect_b32 s57, s58, s57
    v_exp_f32 v24, v24
    v_exp_f32 v25, v25
    v_exp_f32 v26, v26
    v_exp_f32 v27, v27
    v_mfma_f32_32x32x16_bf16 v[48:63], v[104:107], v[100:103], v[48:63]
    v_exp_f32 v28, v28
    v_exp_f32 v29, v29
    v_exp_f32 v30, v30
    v_exp_f32 v31, v31
    v_smfmac_f32_32x32x32_bf16 v[80:95], v[112:115], v[16:23], v122
    ds_read_b128 v[104:107], v252 offset:12288
    buffer_load_dwordx4 v[152:155], v249, s[16:19], s57 offen offset:0 sc1
    v_exp_f32 v32, v32
    v_exp_f32 v33, v33
    v_exp_f32 v34, v34
    v_exp_f32 v35, v35
    v_smfmac_f32_32x32x32_bf16 v[80:95], v[116:119], v[24:31], v122
    buffer_load_dwordx4 v[156:159], v248, s[16:19], s57 offen offset:0 sc1
    s_add_u32 s57, s57, 8192
    s_cmp_eq_u32 s57, s62
    s_cselect_b32 s57, s58, s57
    v_exp_f32 v36, v36
    v_exp_f32 v37, v37
    v_exp_f32 v38, v38
    v_exp_f32 v39, v39
    v_mfma_f32_32x32x4_2b_bf16 v[0:31], v[108:109], v[120:121], 0 cbsz:1 abid:1
    s_mov_b64 exec, s[38:39]
    ds_read_b128 v[112:115], v253 offset:11520
    ds_read_b128 v[116:119], v253 offset:12160
    s_mov_b64 exec, -1
    v_exp_f32 v40, v40
    v_exp_f32 v41, v41
    v_exp_f32 v42, v42
    v_exp_f32 v43, v43
    v_exp_f32 v44, v44
    v_exp_f32 v45, v45
    v_exp_f32 v46, v46
    v_exp_f32 v47, v47
    s_waitcnt lgkmcnt(0)
    v_smfmac_f32_32x32x32_bf16 v[64:79], v[112:115], v[32:39], v122
    v_exp_f32 v48, v48
    v_exp_f32 v49, v49
    v_exp_f32 v50, v50
    v_exp_f32 v51, v51
    v_mfma_f32_32x32x16_bf16 v[0:15], v[104:107], v[96:99], v[0:15]
    buffer_load_dwordx4 v[160:163], v249, s[16:19], s57 offen offset:0 sc1
    v_exp_f32 v52, v52
    v_exp_f32 v53, v53
    v_exp_f32 v54, v54
    v_exp_f32 v55, v55
    v_smfmac_f32_32x32x32_bf16 v[64:79], v[116:119], v[40:47], v122
    buffer_load_dwordx4 v[164:167], v248, s[16:19], s57 offen offset:0 sc1
    s_add_u32 s57, s57, 8192
    s_cmp_eq_u32 s57, s62
    s_cselect_b32 s57, s58, s57
    v_exp_f32 v56, v56
    v_exp_f32 v57, v57
    v_exp_f32 v58, v58
    v_exp_f32 v59, v59
    v_mfma_f32_32x32x16_bf16 v[16:31], v[104:107], v[100:103], v[16:31]
    v_exp_f32 v60, v60
    v_exp_f32 v61, v61
    v_exp_f32 v62, v62
    v_exp_f32 v63, v63
    v_smfmac_f32_32x32x32_bf16 v[80:95], v[112:115], v[48:55], v122
    ds_read_b128 v[104:107], v252 offset:13312
    buffer_load_dwordx4 v[168:171], v249, s[16:19], s57 offen offset:0 sc1
    v_exp_f32 v0, v0
    v_exp_f32 v1, v1
    v_exp_f32 v2, v2
    v_exp_f32 v3, v3
    v_smfmac_f32_32x32x32_bf16 v[80:95], v[116:119], v[56:63], v122
    v_exp_f32 v4, v4
    v_exp_f32 v5, v5
    v_exp_f32 v6, v6
    v_exp_f32 v7, v7
    v_mfma_f32_32x32x4_2b_bf16 v[32:63], v[110:111], v[120:121], 0 cbsz:1 abid:1
    s_mov_b64 exec, s[38:39]
    ds_read_b128 v[112:115], v253 offset:12800
    ds_read_b128 v[116:119], v253 offset:13440
    s_mov_b64 exec, -1
    v_exp_f32 v8, v8
    v_exp_f32 v9, v9
    v_exp_f32 v10, v10
    v_exp_f32 v11, v11
    v_exp_f32 v12, v12
    v_exp_f32 v13, v13
    v_exp_f32 v14, v14
    v_exp_f32 v15, v15
    s_waitcnt lgkmcnt(0)
    v_smfmac_f32_32x32x32_bf16 v[64:79], v[112:115], v[0:7], v122
    v_exp_f32 v16, v16
    v_exp_f32 v17, v17
    v_exp_f32 v18, v18
    v_exp_f32 v19, v19
    v_mfma_f32_32x32x16_bf16 v[32:47], v[104:107], v[96:99], v[32:47]
    buffer_load_dwordx4 v[172:175], v248, s[16:19], s57 offen offset:0 sc1
    s_add_u32 s57, s57, 8192
    s_cmp_eq_u32 s57, s62
    s_cselect_b32 s57, s58, s57
    v_exp_f32 v20, v20
    v_exp_f32 v21, v21
    v_exp_f32 v22, v22
    v_exp_f32 v23, v23
    v_smfmac_f32_32x32x32_bf16 v[64:79], v[116:119], v[8:15], v122
    buffer_load_dwordx4 v[176:179], v249, s[16:19], s57 offen offset:0 sc1
    v_exp_f32 v24, v24
    v_exp_f32 v25, v25
    v_exp_f32 v26, v26
    v_exp_f32 v27, v27
    v_mfma_f32_32x32x16_bf16 v[48:63], v[104:107], v[100:103], v[48:63]
    v_exp_f32 v28, v28
    v_exp_f32 v29, v29
    v_exp_f32 v30, v30
    v_exp_f32 v31, v31
    v_smfmac_f32_32x32x32_bf16 v[80:95], v[112:115], v[16:23], v122
    s_cbranch_vccz L_pr46
    s_setprio 0
L_pr46:
    ds_read_b128 v[108:111], v252 offset:24576
    ds_read_b128 v[104:107], v252 offset:20480
    buffer_load_dwordx4 v[180:183], v248, s[16:19], s57 offen offset:0 sc1
    s_add_u32 s57, s57, 8192
    s_cmp_eq_u32 s57, s62
    s_cselect_b32 s57, s58, s57
    v_exp_f32 v32, v32
    v_exp_f32 v33, v33
    v_exp_f32 v34, v34
    v_exp_f32 v35, v35
    v_smfmac_f32_32x32x32_bf16 v[80:95], v[116:119], v[24:31], v122
    buffer_load_dwordx4 v[184:187], v249, s[16:19], s57 offen offset:0 sc1
    v_exp_f32 v36, v36
    v_exp_f32 v37, v37
    v_exp_f32 v38, v38
    v_exp_f32 v39, v39
    s_waitcnt lgkmcnt(1)
    v_mfma_f32_32x32x4_2b_bf16 v[0:31], v[108:109], v[120:121], 0 cbsz:1 abid:0
    s_mov_b64 exec, s[38:39]
    ds_read_b128 v[112:115], v253 offset:14080
    ds_read_b128 v[116:119], v253 offset:14720
    s_mov_b64 exec, -1
    v_exp_f32 v40, v40
    v_exp_f32 v41, v41
    v_exp_f32 v42, v42
    v_exp_f32 v43, v43
    v_exp_f32 v44, v44
    v_exp_f32 v45, v45
    v_exp_f32 v46, v46
    v_exp_f32 v47, v47
    s_waitcnt lgkmcnt(0)
    v_smfmac_f32_32x32x32_bf16 v[64:79], v[112:115], v[32:39], v122
    v_exp_f32 v48, v48
    v_exp_f32 v49, v49
    v_exp_f32 v50, v50
    v_exp_f32 v51, v51
    v_mfma_f32_32x32x16_bf16 v[0:15], v[104:107], v[96:99], v[0:15]
    buffer_load_dwordx4 v[188:191], v248, s[16:19], s57 offen offset:0 sc1
    s_add_u32 s57, s57, 8192
    s_cmp_eq_u32 s57, s62
    s_cselect_b32 s57, s58, s57
    v_exp_f32 v52, v52
    v_exp_f32 v53, v53
    v_exp_f32 v54, v54
    v_exp_f32 v55, v55
    v_smfmac_f32_32x32x32_bf16 v[64:79], v[116:119], v[40:47], v122
    buffer_load_dwordx4 v[192:195], v249, s[16:19], s57 offen offset:0 sc1
    v_exp_f32 v56, v56
    v_exp_f32 v57, v57
    v_exp_f32 v58, v58
    v_exp_f32 v59, v59
    v_mfma_f32_32x32x16_bf16 v[16:31], v[104:107], v[100:103], v[16:31]
    v_exp_f32 v60, v60
    v_exp_f32 v61, v61
    v_exp_f32 v62, v62
    v_exp_f32 v63, v63
    v_smfmac_f32_32x32x32_bf16 v[80:95], v[112:115], v[48:55], v122
    ds_read_b128 v[104:107], v252 offset:21504
    buffer_load_dwordx4 v[196:199], v248, s[16:19], s57 offen offset:0 sc1
    s_add_u32 s57, s57, 8192
    s_cmp_eq_u32 s57, s62
    s_cselect_b32 s57, s58, s57
    v_exp_f32 v0, v0
    v_exp_f32 v1, v1
    v_exp_f32 v2, v2
    v_exp_f32 v3, v3
    v_smfmac_f32_32x32x32_bf16 v[80:95], v[116:119], v[56:63], v122
    buffer_load_dwordx4 v[200:203], v249, s[16:19], s57 offen offset:0 sc1
    v_exp_f32 v4, v4
    v_exp_f32 v5, v5
    v_exp_f32 v6, v6
    v_exp_f32 v7, v7
    v_mfma_f32_32x32x4_2b_bf16 v[32:63], v[110:111], v[120:121], 0 cbsz:1 abid:0
    s_mov_b64 exec, s[38:39]
    ds_read_b128 v[112:115], v253 offset:20480
    ds_read_b128 v[116:119], v253 offset:21120
    s_mov_b64 exec, -1
    v_exp_f32 v8, v8
    v_exp_f32 v9, v9
    v_exp_f32 v10, v10
    v_exp_f32 v11, v11
    v_exp_f32 v12, v12
    v_exp_f32 v13, v13
    v_exp_f32 v14, v14
    v_exp_f32 v15, v15
    s_waitcnt lgkmcnt(0)
    v_smfmac_f32_32x32x32_bf16 v[64:79], v[112:115], v[0:7], v122
    v_exp_f32 v16, v16
    v_exp_f32 v17, v17
    v_exp_f32 v18, v18
    v_exp_f32 v19, v19
    v_mfma_f32_32x32x16_bf16 v[32:47], v[104:107], v[96:99], v[32:47]
    buffer_load_dwordx4 v[204:207], v248, s[16:19], s57 offen offset:0 sc1
    s_add_u32 s57, s57, 8192
    s_cmp_eq_u32 s57, s62
    s_cselect_b32 s57, s58, s57
    v_exp_f32 v20, v20
    v_exp_f32 v21, v21
    v_exp_f32 v22, v22
    v_exp_f32 v23, v23
    v_smfmac_f32_32x32x32_bf16 v[64:79], v[116:119], v[8:15], v122
    v_exp_f32 v24, v24
    v_exp_f32 v25, v25
    v_exp_f32 v26, v26
    v_exp_f32 v27, v27
    v_mfma_f32_32x32x16_bf16 v[48:63], v[104:107], v[100:103], v[48:63]
    v_exp_f32 v28, v28
    v_exp_f32 v29, v29
    v_exp_f32 v30, v30
    v_exp_f32 v31, v31
    v_smfmac_f32_32x32x32_bf16 v[80:95], v[112:115], v[16:23], v122
    ds_read_b128 v[104:107], v252 offset:22528
    buffer_load_dwordx4 v[208:211], v249, s[16:19], s57 offen offset:0 sc1
    v_exp_f32 v32, v32
    v_exp_f32 v33, v33
    v_exp_f32 v34, v34
    v_exp_f32 v35, v35
    v_smfmac_f32_32x32x32_bf16 v[80:95], v[116:119], v[24:31], v122
    buffer_load_dwordx4 v[212:215], v248, s[16:19], s57 offen offset:0 sc1
    s_add_u32 s57, s57, 8192
    s_cmp_eq_u32 s57, s62
    s_cselect_b32 s57, s58, s57
    v_exp_f32 v36, v36
    v_exp_f32 v37, v37
    v_exp_f32 v38, v38
    v_exp_f32 v39, v39
    v_mfma_f32_32x32x4_2b_bf16 v[0:31], v[108:109], v[120:121], 0 cbsz:1 abid:1
    s_mov_b64 exec, s[38:39]
    ds_read_b128 v[112:115], v253 offset:21760
    ds_read_b128 v[116:119], v253 offset:22400
    s_mov_b64 exec, -1
    v_exp_f32 v40, v40
    v_exp_f32 v41, v41
    v_exp_f32 v42, v42
    v_exp_f32 v43, v43
    v_exp_f32 v44, v44
    v_exp_f32 v45, v45
    v_exp_f32 v46, v46
    v_exp_f32 v47, v47
    s_waitcnt lgkmcnt(0)
    v_smfmac_f32_32x32x32_bf16 v[64:79], v[112:115], v[32:39], v122
    v_exp_f32 v48, v48
    v_exp_f32 v49, v49
    v_exp_f32 v50, v50
    v_exp_f32 v51, v51
    v_mfma_f32_32x32x16_bf16 v[0:15], v[104:107], v[96:99], v[0:15]
    buffer_load_dwordx4 v[216:219], v249, s[16:19], s57 offen offset:0 sc1
    v_exp_f32 v52, v52
    v_exp_f32 v53, v53
    v_exp_f32 v54, v54
    v_exp_f32 v55, v55
    v_smfmac_f32_32x32x32_bf16 v[64:79], v[116:119], v[40:47], v122
    buffer_load_dwordx4 v[220:223], v248, s[16:19], s57 offen offset:0 sc1
    s_add_u32 s57, s57, 8192
    s_cmp_eq_u32 s57, s62
    s_cselect_b32 s57, s58, s57
    v_exp_f32 v56, v56
    v_exp_f32 v57, v57
    v_exp_f32 v58, v58
    v_exp_f32 v59, v59
    v_mfma_f32_32x32x16_bf16 v[16:31], v[104:107], v[100:103], v[16:31]
    v_exp_f32 v60, v60
    v_exp_f32 v61, v61
    v_exp_f32 v62, v62
    v_exp_f32 v63, v63
    v_smfmac_f32_32x32x32_bf16 v[80:95], v[112:115], v[48:55], v122
    ds_read_b128 v[104:107], v252 offset:23552
    v_exp_f32 v0, v0
    v_exp_f32 v1, v1
    v_exp_f32 v2, v2
    v_exp_f32 v3, v3
    v_smfmac_f32_32x32x32_bf16 v[80:95], v[116:119], v[56:63], v122
    v_exp_f32 v4, v4
    v_exp_f32 v5, v5
    v_exp_f32 v6, v6
    v_exp_f32 v7, v7
    v_mfma_f32_32x32x4_2b_bf16 v[32:63], v[110:111], v[120:121], 0 cbsz:1 abid:1
    s_mov_b64 exec, s[38:39]
    ds_read_b128 v[112:115], v253 offset:23040
    ds_read_b128 v[116:119], v253 offset:23680
    s_mov_b64 exec, -1
    v_exp_f32 v8, v8
    v_exp_f32 v9, v9
    v_exp_f32 v10, v10
    v_exp_f32 v11, v11
    v_exp_f32 v12, v12
    v_exp_f32 v13, v13
    v_exp_f32 v14, v14
    v_exp_f32 v15, v15
    s_waitcnt lgkmcnt(0)
    v_smfmac_f32_32x32x32_bf16 v[64:79], v[112:115], v[0:7], v122
    v_exp_f32 v16, v16
    v_exp_f32 v17, v17
    v_exp_f32 v18, v18
    v_exp_f32 v19, v19
    v_mfma_f32_32x32x16_bf16 v[32:47], v[104:107], v[96:99], v[32:47]
    v_exp_f32 v20, v20
    v_exp_f32 v21, v21
    v_exp_f32 v22, v22
    v_exp_f32 v23, v23
    v_smfmac_f32_32x32x32_bf16 v[64:79], v[116:119], v[8:15], v122
    v_exp_f32 v24, v24
    v_exp_f32 v25, v25
    v_exp_f32 v26, v26
    v_exp_f32 v27, v27
    v_mfma_f32_32x32x16_bf16 v[48:63], v[104:107], v[100:103], v[48:63]
    v_exp_f32 v28, v28
    v_exp_f32 v29, v29
    v_exp_f32 v30, v30
    v_exp_f32 v31, v31
    v_smfmac_f32_32x32x32_bf16 v[80:95], v[112:115], v[16:23], v122
    ds_read_b128 v[108:111], v252 offset:34816
    ds_read_b128 v[104:107], v252 offset:30720
    v_exp_f32 v32, v32
    v_exp_f32 v33, v33
    v_exp_f32 v34, v34
    v_exp_f32 v35, v35
    v_smfmac_f32_32x32x32_bf16 v[80:95], v[116:119], v[24:31], v122
    v_exp_f32 v36, v36
    v_exp_f32 v37, v37
    v_exp_f32 v38, v38
    v_exp_f32 v39, v39
    s_waitcnt lgkmcnt(1)
    v_mfma_f32_32x32x4_2b_bf16 v[0:31], v[108:109], v[120:121], 0 cbsz:1 abid:0
    s_mov_b64 exec, s[38:39]
    ds_read_b128 v[112:115], v253 offset:24320
    ds_read_b128 v[116:119], v253 offset:24960
    s_mov_b64 exec, -1
    v_exp_f32 v40, v40
    v_exp_f32 v41, v41
    v_exp_f32 v42, v42
    v_exp_f32 v43, v43
    v_exp_f32 v44, v44
    v_exp_f32 v45, v45
    v_exp_f32 v46, v46
    v_exp_f32 v47, v47
    s_waitcnt lgkmcnt(0)
    v_smfmac_f32_32x32x32_bf16 v[64:79], v[112:115], v[32:39], v122
    v_exp_f32 v48, v48
    v_exp_f32 v49, v49
    v_exp_f32 v50, v50
    v_exp_f32 v51, v51
    v_mfma_f32_32x32x16_bf16 v[0:15], v[104:107], v[96:99], v[0:15]
    v_exp_f32 v52, v52
    v_exp_f32 v53, v53
    v_exp_f32 v54, v54
    v_exp_f32 v55, v55
    v_smfmac_f32_32x32x32_bf16 v[64:79], v[116:119], v[40:47], v122
    v_exp_f32 v56, v56
    v_exp_f32 v57, v57
    v_exp_f32 v58, v58
    v_exp_f32 v59, v59
    v_mfma_f32_32x32x16_bf16 v[16:31], v[104:107], v[100:103], v[16:31]
    v_exp_f32 v60, v60
    v_exp_f32 v61, v61
    v_exp_f32 v62, v62
    v_exp_f32 v63, v63
    v_smfmac_f32_32x32x32_bf16 v[80:95], v[112:115], v[48:55], v122
    s_waitcnt vmcnt(0)
    s_barrier
    s_cbranch_vccz L_pr56
    s_setprio 1
L_pr56:
    ds_read_b128 v[104:107], v252 offset:31744
    s_add_u32 m0, s65, 20480
    s_nop 0
    buffer_load_dwordx4 v255, s[16:19], s56 offen offset:0 sc1 lds
    v_exp_f32 v0, v0
    v_exp_f32 v1, v1
    v_exp_f32 v2, v2
    v_exp_f32 v3, v3
    v_smfmac_f32_32x32x32_bf16 v[80:95], v[116:119], v[56:63], v122
    buffer_load_dwordx4 v255, s[16:19], s56 offen offset:1024 sc1 lds
    v_exp_f32 v4, v4
    v_exp_f32 v5, v5
    v_exp_f32 v6, v6
    v_exp_f32 v7, v7
    v_mfma_f32_32x32x4_2b_bf16 v[32:63], v[110:111], v[120:121], 0 cbsz:1 abid:0
    s_mov_b64 exec, s[38:39]
    ds_read_b128 v[112:115], v253 offset:30720
    ds_read_b128 v[116:119], v253 offset:31360
    s_mov_b64 exec, -1
    v_exp_f32 v8, v8
    v_exp_f32 v9, v9
    v_exp_f32 v10, v10
    v_exp_f32 v11, v11
    v_exp_f32 v12, v12
    v_exp_f32 v13, v13
    v_exp_f32 v14, v14
    v_exp_f32 v15, v15
    s_waitcnt lgkmcnt(0)
    v_smfmac_f32_32x32x32_bf16 v[64:79], v[112:115], v[0:7], v122
    v_exp_f32 v16, v16
    v_exp_f32 v17, v17
    v_exp_f32 v18, v18
    v_exp_f32 v19, v19
    v_mfma_f32_32x32x16_bf16 v[32:47], v[104:107], v[96:99], v[32:47]
    s_cbranch_vccnz L_pc10
    buffer_load_dwordx4 v255, s[16:19], s56 offen offset:2048 sc1 lds
L_pc10:
    s_add_u32 s56, s56, 20480
    s_cmp_eq_u32 s56, s61
    s_cselect_b32 s56, s60, s56
    v_exp_f32 v20, v20
    v_exp_f32 v21, v21
    v_exp_f32 v22, v22
    v_exp_f32 v23, v23
    v_smfmac_f32_32x32x32_bf16 v[64:79], v[116:119], v[8:15], v122
    s_add_u32 m0, s65, 30720
    s_nop 0
    buffer_load_dwordx4 v255, s[16:19], s56 offen offset:0 sc1 lds
    v_exp_f32 v24, v24
    v_exp_f32 v25, v25
    v_exp_f32 v26, v26
    v_exp_f32 v27, v27
    v_mfma_f32_32x32x16_bf16 v[48:63], v[104:107], v[100:103], v[48:63]
    v_exp_f32 v28, v28
    v_exp_f32 v29, v29
    v_exp_f32 v30, v30
    v_exp_f32 v31, v31
    v_smfmac_f32_32x32x32_bf16 v[80:95], v[112:115], v[16:23], v122
    ds_read_b128 v[104:107], v252 offset:32768
    buffer_load_dwordx4 v255, s[16:19], s56 offen offset:1024 sc1 lds
    v_exp_f32 v32, v32
    v_exp_f32 v33, v33
    v_exp_f32 v34, v34
    v_exp_f32 v35, v35
    v_smfmac_f32_32x32x32_bf16 v[80:95], v[116:119], v[24:31], v122
    s_cbranch_vccnz L_pc11
    buffer_load_dwordx4 v255, s[16:19], s56 offen offset:2048 sc1 lds
L_pc11:
    s_add_u32 s56, s56, 20480
    s_cmp_eq_u32 s56, s61
    s_cselect_b32 s56, s60, s56
    v_exp_f32 v36, v36
    v_exp_f32 v37, v37
    v_exp_f32 v38, v38
    v_exp_f32 v39, v39
    v_mfma_f32_32x32x4_2b_bf16 v[0:31], v[108:109], v[120:121], 0 cbsz:1 abid:1
    s_mov_b64 exec, s[38:39]
    ds_read_b128 v[112:115], v253 offset:32000
    ds_read_b128 v[116:119], v253 offset:32640
    s_mov_b64 exec, -1
    v_exp_f32 v40, v40
    v_exp_f32 v41, v41
    v_exp_f32 v42, v42
    v_exp_f32 v43, v43
    v_exp_f32 v44, v44
    v_exp_f32 v45, v45
    v_exp_f32 v46, v46
    v_exp_f32 v47, v47
    s_waitcnt lgkmcnt(0)
    v_smfmac_f32_32x32x32_bf16 v[64:79], v[112:115], v[32:39], v122
    v_exp_f32 v48, v48
    v_exp_f32 v49, v49
    v_exp_f32 v50, v50
    v_exp_f32 v51, v51
    v_mfma_f32_32x32x16_bf16 v[0:15], v[104:107], v[96:99], v[0:15]
    s_add_u32 m0, s65, 40960
    s_nop 0
    buffer_load_dwordx4 v255, s[16:19], s56 offen offset:0 sc1 lds
    v_exp_f32 v52, v52
    v_exp_f32 v53, v53
    v_exp_f32 v54, v54
    v_exp_f32 v55, v55
    v_smfmac_f32_32x32x32_bf16 v[64:79], v[116:119], v[40:47], v122
    buffer_load_dwordx4 v255, s[16:19], s56 offen offset:1024 sc1 lds
    v_exp_f32 v56, v56
    v_exp_f32 v57, v57
    v_exp_f32 v58, v58
    v_exp_f32 v59, v59
    v_mfma_f32_32x32x16_bf16 v[16:31], v[104:107], v[100:103], v[16:31]
    v_exp_f32 v60, v60
    v_exp_f32 v61, v61
    v_exp_f32 v62, v62
    v_exp_f32 v63, v63
    v_smfmac_f32_32x32x32_bf16 v[80:95], v[112:115], v[48:55], v122
    ds_read_b128 v[104:107], v252 offset:33792
    s_cbranch_vccnz L_pc12
    buffer_load_dwordx4 v255, s[16:19], s56 offen offset:2048 sc1 lds
L_pc12:
    s_add_u32 s56, s56, 20480
    s_cmp_eq_u32 s56, s61
    s_cselect_b32 s56, s60, s56
    v_exp_f32 v0, v0
    v_exp_f32 v1, v1
    v_exp_f32 v2, v2
    v_exp_f32 v3, v3
    v_smfmac_f32_32x32x32_bf16 v[80:95], v[116:119], v[56:63], v122
    s_add_u32 m0, s65, 51200
    s_nop 0
    buffer_load_dwordx4 v255, s[16:19], s56 offen offset:0 sc1 lds
    v_exp_f32 v4, v4
    v_exp_f32 v5, v5
    v_exp_f32 v6, v6
    v_exp_f32 v7, v7
    v_mfma_f32_32x32x4_2b_bf16 v[32:63], v[110:111], v[120:121], 0 cbsz:1 abid:1
    s_mov_b64 exec, s[38:39]
    ds_read_b128 v[112:115], v253 offset:33280
    ds_read_b128 v[116:119], v253 offset:33920
    s_mov_b64 exec, -1
    v_exp_f32 v8, v8
    v_exp_f32 v9, v9
    v_exp_f32 v10, v10
    v_exp_f32 v11, v11
    v_exp_f32 v12, v12
    v_exp_f32 v13, v13
    v_exp_f32 v14, v14
    v_exp_f32 v15, v15
    s_waitcnt lgkmcnt(0)
    v_smfmac_f32_32x32x32_bf16 v[64:79], v[112:115], v[0:7], v122
    v_exp_f32 v16, v16
    v_exp_f32 v17, v17
    v_exp_f32 v18, v18
    v_exp_f32 v19, v19
    v_mfma_f32_32x32x16_bf16 v[32:47], v[104:107], v[96:99], v[32:47]
    buffer_load_dwordx4 v255, s[16:19], s56 offen offset:1024 sc1 lds
    v_exp_f32 v20, v20
    v_exp_f32 v21, v21
    v_exp_f32 v22, v22
    v_exp_f32 v23, v23
    v_smfmac_f32_32x32x32_bf16 v[64:79], v[116:119], v[8:15], v122
    s_cbranch_vccnz L_pc13
    buffer_load_dwordx4 v255, s[16:19], s56 offen offset:2048 sc1 lds
L_pc13:
    s_add_u32 s56, s56, 20480
    s_cmp_eq_u32 s56, s61
    s_cselect_b32 s56, s60, s56
    v_exp_f32 v24, v24
    v_exp_f32 v25, v25
    v_exp_f32 v26, v26
    v_exp_f32 v27, v27
    v_mfma_f32_32x32x16_bf16 v[48:63], v[104:107], v[100:103], v[48:63]
    v_exp_f32 v28, v28
    v_exp_f32 v29, v29
    v_exp_f32 v30, v30
    v_exp_f32 v31, v31
    v_smfmac_f32_32x32x32_bf16 v[80:95], v[112:115], v[16:23], v122
    s_cbranch_vccz L_pr62
    s_setprio 0
L_pr62:
    v_exp_f32 v32, v32
    v_exp_f32 v33, v33
    v_exp_f32 v34, v34
    v_exp_f32 v35, v35
    v_smfmac_f32_32x32x32_bf16 v[80:95], v[116:119], v[24:31], v122
    v_exp_f32 v36, v36
    v_exp_f32 v37, v37
    v_exp_f32 v38, v38
    v_exp_f32 v39, v39
    s_mov_b64 exec, s[38:39]
    ds_read_b128 v[112:115], v253 offset:34560
    ds_read_b128 v[116:119], v253 offset:35200
    s_mov_b64 exec, -1
    v_exp_f32 v40, v40
    v_exp_f32 v41, v41
    v_exp_f32 v42, v42
    v_exp_f32 v43, v43
    v_exp_f32 v44, v44
    v_exp_f32 v45, v45
    v_exp_f32 v46, v46
    v_exp_f32 v47, v47
    s_waitcnt lgkmcnt(0)
    v_smfmac_f32_32x32x32_bf16 v[64:79], v[112:115], v[32:39], v122
    v_exp_f32 v48, v48
    v_exp_f32 v49, v49
    v_exp_f32 v50, v50
    v_exp_f32 v51, v51
    v_exp_f32 v52, v52
    v_exp_f32 v53, v53
    v_exp_f32 v54, v54
    v_exp_f32 v55, v55
    v_smfmac_f32_32x32x32_bf16 v[64:79], v[116:119], v[40:47], v122
    v_exp_f32 v56, v56
    v_exp_f32 v57, v57
    v_exp_f32 v58, v58
    v_exp_f32 v59, v59
    v_exp_f32 v60, v60
    v_exp_f32 v61, v61
    v_exp_f32 v62, v62
    v_exp_f32 v63, v63
    v_smfmac_f32_32x32x32_bf16 v[80:95], v[112:115], v[48:55], v122
    s_nop 0
    v_smfmac_f32_32x32x32_bf16 v[80:95], v[116:119], v[56:63], v122
    s_mul_i32 s31, s28, 2560
    s_add_u32 s31, s31, 20480
    v_add_u32 v104, s31, v252
    s_and_b32 s13, s28, 1
    s_lshl_b32 s13, s13, 9
    s_lshr_b32 s12, s28, 1
    s_lshl_b32 s12, s12, 12
    s_add_u32 s13, s13, s12
    s_add_u32 s13, s13, 30208
    v_add_u32 v106, 2048, v104
    s_mov_b32 exec_lo, 0
    v_add_u32 v106, s13, v252
    s_mov_b64 exec, -1
    s_mul_i32 s31, s27, 163840
    s_sub_u32 s31, 81920, s31
    s_cmp_eq_u32 s27, 0
    v_add_u32 v105, s31, v104
    v_add_u32 v107, s31, v106
    s_cbranch_scc0 L_at_z1
    ds_write_b128 v104, v[80:83] offset:0
    ds_write_b128 v104, v[84:87] offset:1024
    ds_write_b128 v106, v[88:91] offset:0
L_at_zj:
    s_waitcnt lgkmcnt(0)
    s_barrier
    ds_read_b128 v[0:3], v105 offset:0
    ds_read_b128 v[4:7], v105 offset:1024
    ds_read_b128 v[8:11], v107 offset:0
    s_waitcnt lgkmcnt(0)
    v_pk_add_f32 v[72:73], v[72:73], v[8:9]
    v_pk_add_f32 v[64:65], v[64:65], v[0:1]
    v_pk_add_f32 v[66:67], v[66:67], v[2:3]
    v_pk_add_f32 v[68:69], v[68:69], v[4:5]
    v_pk_add_f32 v[70:71], v[70:71], v[6:7]
    v_pk_add_f32 v[74:75], v[74:75], v[10:11]
    v_mov_b32 v106, v72
    v_mov_b32 v107, v72
    v_pk_add_f32 v[0:1], v[64:65], v[66:67]
    v_pk_add_f32 v[2:3], v[68:69], v[70:71]
    v_permlane32_swap_b32 v107, v106
    v_pk_add_f32 v[4:5], v[72:73], v[74:75]
    v_pk_add_f32 v[0:1], v[0:1], v[2:3]
    v_pk_add_f32 v[0:1], v[0:1], v[4:5]
    v_add_f32 v104, abs(v0), abs(v1)
    v_rcp_f32 v105, v106
    v_cmp_nle_f32 vcc, 0x2b800000, v106
    s_mov_b64 s[40:41], vcc
    v_cmp_nge_f32 vcc, 0x71800000, v106
    s_or_b64 s[40:41], s[40:41], vcc
    v_cmp_nge_f32 vcc, 0x7e800000, v104
    s_or_b64 s[40:41], s[40:41], vcc
    s_cmp_lg_u64 s[40:41], 0
    s_cbranch_scc1 L_at_slow
L_at_store:
    v_mul_f32 v105, v105, v123
    v_pk_mul_f32 v[72:73], v[72:73], v[104:105] op_sel:[0,1] op_sel_hi:[1,1]
    v_pk_mul_f32 v[74:75], v[74:75], v[104:105] op_sel:[0,1] op_sel_hi:[1,1]
    v_pk_mul_f32 v[64:65], v[64:65], v[104:105] op_sel:[0,1] op_sel_hi:[1,1]
    v_pk_mul_f32 v[66:67], v[66:67], v[104:105] op_sel:[0,1] op_sel_hi:[1,1]
    v_pk_mul_f32 v[68:69], v[68:69], v[104:105] op_sel:[0,1] op_sel_hi:[1,1]
    v_pk_mul_f32 v[70:71], v[70:71], v[104:105] op_sel:[0,1] op_sel_hi:[1,1]
    v_cvt_pk_bf16_f32 v4, v72, v73
    v_cvt_pk_bf16_f32 v5, v74, v75
    v_cvt_pk_bf16_f32 v0, v64, v65
    v_cvt_pk_bf16_f32 v1, v66, v67
    v_cvt_pk_bf16_f32 v2, v68, v69
    v_cvt_pk_bf16_f32 v3, v70, v71
    v_min_u32 v4, -2, v4
    v_min_u32 v5, -2, v5
    v_min_u32 v0, -2, v0
    v_min_u32 v1, -2, v1
    v_min_u32 v2, -2, v2
    v_min_u32 v3, -2, v3
    v_permlane16_swap_b32 v4, v6
    v_permlane16_swap_b32 v5, v7
    buffer_store_dwordx4 v[0:3], v126, s[16:19], s32 offen sc1
    s_mov_b64 exec, 0xffff
    buffer_store_dwordx4 v[4:7], v255, s[16:19], s33 offen sc1
    s_mov_b64 exec, -1
    ds_read_b128 v[80:83], v224 offset:0
    ds_read_b128 v[84:87], v225 offset:0
    ds_read_b128 v[88:91], v226 offset:0
    ds_read_b128 v[92:95], v227 offset:0
    ds_read_b128 v[96:99], v228 offset:0
    s_cmp_eq_u32 s27, 0
    s_cselect_b64 vcc, 0, -1
    s_waitcnt lgkmcnt(4)
    v_mfma_f32_16x16x32_bf16 v[40:43], v[80:83], v[128:131], 0
    s_waitcnt vmcnt(8)
    s_barrier
    ds_read_b128 v[100:103], v224 offset:10240
    v_add_u32 v240, 32768, v249
    v_and_b32 v120, 0x600, v249
    v_mfma_f32_16x16x32_bf16 v[60:63], v[80:83], v[132:135], 0
    s_add_u32 m0, s65, 71680
    s_nop 0
    buffer_load_dwordx4 v255, s[16:19], s56 offen offset:0 sc1 lds
    v_add_u32 v120, v120, v249
    v_bfe_u32 v121, v255, 4, 4
    s_waitcnt lgkmcnt(4)
    v_mfma_f32_16x16x32_bf16 v[44:47], v[84:87], v[128:131], 0
    ds_read_b128 v[104:107], v225 offset:10240
    v_mul_u32_u24 v121, 1280, v121
    v_mfma_f32_16x16x32_bf16 v[64:67], v[84:87], v[132:135], 0
    v_bfe_u32 v126, v255, 8, 1
    s_waitcnt lgkmcnt(4)
    v_mfma_f32_16x16x32_bf16 v[48:51], v[88:91], v[128:131], 0
    ds_read_b128 v[108:111], v226 offset:10240
    buffer_load_dwordx4 v255, s[16:19], s56 offen offset:1024 sc1 lds
    v_mul_u32_u24 v126, 40960, v126
    v_mfma_f32_16x16x32_bf16 v[68:71], v[88:91], v[132:135], 0
    v_lshrrev_b32 v127, 9, v255
    s_waitcnt lgkmcnt(4)
    v_mfma_f32_16x16x32_bf16 v[52:55], v[92:95], v[128:131], 0
    ds_read_b128 v[112:115], v227 offset:10240
    v_lshl_add_u32 v126, v127, 4, v126
    v_mfma_f32_16x16x32_bf16 v[72:75], v[92:95], v[132:135], 0
    s_cbranch_vccnz L_pc14
    buffer_load_dwordx4 v255, s[16:19], s56 offen offset:2048 sc1 lds
L_pc14:
    s_add_u32 s56, s56, 20480
    s_cmp_eq_u32 s56, s61
    s_cselect_b32 s56, s60, s56
    v_add_u32 v126, v126, v121
    s_waitcnt lgkmcnt(4)
    v_mfma_f32_16x16x32_bf16 v[56:59], v[96:99], v[128:131], 0
    ds_read_b128 v[116:119], v228 offset:10240
    v_lshrrev_b32 v127, 8, v255
    v_mfma_f32_16x16x32_bf16 v[76:79], v[96:99], v[132:135], 0
    v_lshl_add_u32 v127, v127, 3, v121
    s_waitcnt lgkmcnt(4)
    v_mfma_f32_16x16x32_bf16 v[40:43], v[100:103], v[136:139], v[40:43]
    ds_read_b128 v[80:83], v224 offset:20480
    v_sub_f32 v122, 1.0, v124
    v_mfma_f32_16x16x32_bf16 v[60:63], v[100:103], v[140:143], v[60:63]
    s_add_u32 m0, s65, 61440
    s_nop 0
    buffer_load_dwordx4 v255, s[16:19], s56 offen offset:0 sc1 lds
    v_cvt_pk_bf16_f32 v122, v122, v122
    s_waitcnt lgkmcnt(4)
    v_mfma_f32_16x16x32_bf16 v[44:47], v[104:107], v[136:139], v[44:47]
    ds_read_b128 v[84:87], v225 offset:20480
    v_and_b32 v122, 0xffff0000, v122
    v_mfma_f32_16x16x32_bf16 v[64:67], v[104:107], v[140:143], v[64:67]
    v_sub_f32 v123, 1.0, v125
    s_waitcnt lgkmcnt(4)
    v_mfma_f32_16x16x32_bf16 v[48:51], v[108:111], v[136:139], v[48:51]
    ds_read_b128 v[88:91], v226 offset:20480
    buffer_load_dwordx4 v255, s[16:19], s56 offen offset:1024 sc1 lds
    v_cvt_pk_bf16_f32 v123, v123, v123
    v_mfma_f32_16x16x32_bf16 v[68:71], v[108:111], v[140:143], v[68:71]
    v_and_b32 v123, 0xffff0000, v123
    s_waitcnt lgkmcnt(4)
    v_mfma_f32_16x16x32_bf16 v[52:55], v[112:115], v[136:139], v[52:55]
    ds_read_b128 v[92:95], v227 offset:20480
    v_mfma_f32_16x16x32_bf16 v[72:75], v[112:115], v[140:143], v[72:75]
    s_cbranch_vccnz L_pc15
    buffer_load_dwordx4 v255, s[16:19], s56 offen offset:2048 sc1 lds
L_pc15:
    s_add_u32 s56, s56, 20480
    s_cmp_eq_u32 s56, s61
    s_cselect_b32 s56, s60, s56
    s_waitcnt lgkmcnt(4)
    v_mfma_f32_16x16x32_bf16 v[56:59], v[116:119], v[136:139], v[56:59]
    ds_read_b128 v[96:99], v228 offset:20480
    v_mfma_f32_16x16x32_bf16 v[76:79], v[116:119], v[140:143], v[76:79]
    s_waitcnt lgkmcnt(4)
    v_mfma_f32_16x16x32_bf16 v[40:43], v[80:83], v[144:147], v[40:43]
    s_waitcnt vmcnt(8)
    s_barrier
    ds_read_b128 v[100:103], v224 offset:30720
    s_lshr_b32 s12, s24, 1
    v_mfma_f32_16x16x32_bf16 v[60:63], v[80:83], v[148:151], v[60:63]
    s_add_u32 m0, s65, 0
    s_nop 0
    buffer_load_dwordx4 v255, s[16:19], s56 offen offset:0 sc1 lds
    s_mul_i32 s13, s3, 81920
    s_waitcnt lgkmcnt(4)
    v_mfma_f32_16x16x32_bf16 v[44:47], v[84:87], v[144:147], v[44:47]
    ds_read_b128 v[104:107], v225 offset:30720
    s_add_u32 s13, s13, 10240
    v_mfma_f32_16x16x32_bf16 v[64:67], v[84:87], v[148:151], v[64:67]
    v_add_u32 v234, s13, v255
    s_waitcnt lgkmcnt(4)
    v_mfma_f32_16x16x32_bf16 v[48:51], v[88:91], v[144:147], v[48:51]
    ds_read_b128 v[108:111], v226 offset:30720
    buffer_load_dwordx4 v255, s[16:19], s56 offen offset:1024 sc1 lds
    s_lshl_b32 s31, s12, 10
    v_mfma_f32_16x16x32_bf16 v[68:71], v[88:91], v[148:151], v[68:71]
    s_add_u32 s31, s31, 24576
    s_waitcnt lgkmcnt(4)
    v_mfma_f32_16x16x32_bf16 v[52:55], v[92:95], v[144:147], v[52:55]
    ds_read_b128 v[112:115], v227 offset:30720
    v_add_u32 v238, s31, v234
    v_mfma_f32_16x16x32_bf16 v[72:75], v[92:95], v[148:151], v[72:75]
    s_cbranch_vccnz L_pc16
    buffer_load_dwordx4 v255, s[16:19], s56 offen offset:2048 sc1 lds
L_pc16:
    s_add_u32 s56, s56, 20480
    s_cmp_eq_u32 s56, s61
    s_cselect_b32 s56, s60, s56
    s_waitcnt lgkmcnt(4)
    v_mfma_f32_16x16x32_bf16 v[56:59], v[96:99], v[144:147], v[56:59]
    ds_read_b128 v[116:119], v228 offset:30720
    v_mfma_f32_16x16x32_bf16 v[76:79], v[96:99], v[148:151], v[76:79]
    s_waitcnt lgkmcnt(4)
    v_mfma_f32_16x16x32_bf16 v[40:43], v[100:103], v[152:155], v[40:43]
    ds_read_b128 v[80:83], v224 offset:40960
    s_xor_b32 s31, s12, 1
    s_mul_i32 s31, s31, 6144
    v_mfma_f32_16x16x32_bf16 v[60:63], v[100:103], v[156:159], v[60:63]
    s_add_u32 m0, s65, 10240
    s_nop 0
    buffer_load_dwordx4 v255, s[16:19], s56 offen offset:0 sc1 lds
    v_add_u32 v235, s31, v234
    s_waitcnt lgkmcnt(4)
    v_mfma_f32_16x16x32_bf16 v[44:47], v[104:107], v[152:155], v[44:47]
    ds_read_b128 v[84:87], v225 offset:40960
    s_xor_b32 s31, s12, 2
    v_mfma_f32_16x16x32_bf16 v[64:67], v[104:107], v[156:159], v[64:67]
    s_mul_i32 s31, s31, 6144
    s_waitcnt lgkmcnt(4)
    v_mfma_f32_16x16x32_bf16 v[48:51], v[108:111], v[152:155], v[48:51]
    ds_read_b128 v[88:91], v226 offset:40960
    buffer_load_dwordx4 v255, s[16:19], s56 offen offset:1024 sc1 lds
    v_add_u32 v236, s31, v234
    v_mfma_f32_16x16x32_bf16 v[68:71], v[108:111], v[156:159], v[68:71]
    s_xor_b32 s31, s12, 3
    s_waitcnt lgkmcnt(4)
    v_mfma_f32_16x16x32_bf16 v[52:55], v[112:115], v[152:155], v[52:55]
    ds_read_b128 v[92:95], v227 offset:40960
    s_mul_i32 s31, s31, 6144
    v_mfma_f32_16x16x32_bf16 v[72:75], v[112:115], v[156:159], v[72:75]
    s_cbranch_vccnz L_pc17
    buffer_load_dwordx4 v255, s[16:19], s56 offen offset:2048 sc1 lds
L_pc17:
    s_add_u32 s56, s56, 20480
    s_cmp_eq_u32 s56, s61
    s_cselect_b32 s56, s60, s56
    v_add_u32 v237, s31, v234
    s_waitcnt lgkmcnt(4)
    v_mfma_f32_16x16x32_bf16 v[56:59], v[116:119], v[152:155], v[56:59]
    ds_read_b128 v[96:99], v228 offset:40960
    s_mul_i32 s31, s12, 6144
    v_mfma_f32_16x16x32_bf16 v[76:79], v[116:119], v[156:159], v[76:79]
    v_add_u32 v239, s31, v234
    s_waitcnt lgkmcnt(4)
    v_mfma_f32_16x16x32_bf16 v[40:43], v[80:83], v[160:163], v[40:43]
    s_waitcnt vmcnt(6)
    s_barrier
    ds_read_b128 v[100:103], v224 offset:51200
    v_mfma_f32_16x16x32_bf16 v[60:63], v[80:83], v[164:167], v[60:63]
    s_add_u32 m0, s65, 20480
    s_nop 0
    buffer_load_dwordx4 v255, s[16:19], s56 offen offset:0 sc1 lds
    s_waitcnt lgkmcnt(4)
    v_mfma_f32_16x16x32_bf16 v[44:47], v[84:87], v[160:163], v[44:47]
    ds_read_b128 v[104:107], v225 offset:51200
    v_mfma_f32_16x16x32_bf16 v[64:67], v[84:87], v[164:167], v[64:67]
    s_waitcnt lgkmcnt(4)
    v_mfma_f32_16x16x32_bf16 v[48:51], v[88:91], v[160:163], v[48:51]
    ds_read_b128 v[108:111], v226 offset:51200
    buffer_load_dwordx4 v255, s[16:19], s56 offen offset:1024 sc1 lds
    v_mfma_f32_16x16x32_bf16 v[68:71], v[88:91], v[164:167], v[68:71]
    s_waitcnt lgkmcnt(4)
    v_mfma_f32_16x16x32_bf16 v[52:55], v[92:95], v[160:163], v[52:55]
    ds_read_b128 v[112:115], v227 offset:51200
    v_mfma_f32_16x16x32_bf16 v[72:75], v[92:95], v[164:167], v[72:75]
    s_cbranch_vccnz L_pc18
    buffer_load_dwordx4 v255, s[16:19], s56 offen offset:2048 sc1 lds
L_pc18:
    s_add_u32 s56, s56, 20480
    s_cmp_eq_u32 s56, s61
    s_cselect_b32 s56, s60, s56
    s_waitcnt lgkmcnt(4)
    v_mfma_f32_16x16x32_bf16 v[56:59], v[96:99], v[160:163], v[56:59]
    ds_read_b128 v[116:119], v228 offset:51200
    v_mfma_f32_16x16x32_bf16 v[76:79], v[96:99], v[164:167], v[76:79]
    s_waitcnt lgkmcnt(4)
    v_mfma_f32_16x16x32_bf16 v[40:43], v[100:103], v[168:171], v[40:43]
    ds_read_b128 v[80:83], v229 offset:0
    v_mfma_f32_16x16x32_bf16 v[60:63], v[100:103], v[172:175], v[60:63]
    s_add_u32 m0, s65, 30720
    s_nop 0
    buffer_load_dwordx4 v255, s[16:19], s56 offen offset:0 sc1 lds
    s_waitcnt lgkmcnt(4)
    v_mfma_f32_16x16x32_bf16 v[44:47], v[104:107], v[168:171], v[44:47]
    ds_read_b128 v[84:87], v230 offset:0
    v_mfma_f32_16x16x32_bf16 v[64:67], v[104:107], v[172:175], v[64:67]
    s_waitcnt lgkmcnt(4)
    v_mfma_f32_16x16x32_bf16 v[48:51], v[108:111], v[168:171], v[48:51]
    ds_read_b128 v[88:91], v231 offset:0
    buffer_load_dwordx4 v255, s[16:19], s56 offen offset:1024 sc1 lds
    v_mfma_f32_16x16x32_bf16 v[68:71], v[108:111], v[172:175], v[68:71]
    s_waitcnt lgkmcnt(4)
    v_mfma_f32_16x16x32_bf16 v[52:55], v[112:115], v[168:171], v[52:55]
    ds_read_b128 v[92:95], v232 offset:0
    v_mfma_f32_16x16x32_bf16 v[72:75], v[112:115], v[172:175], v[72:75]
    s_cbranch_vccnz L_pc19
    buffer_load_dwordx4 v255, s[16:19], s56 offen offset:2048 sc1 lds
L_pc19:
    s_add_u32 s56, s56, 20480
    s_cmp_eq_u32 s56, s61
    s_cselect_b32 s56, s60, s56
    s_waitcnt lgkmcnt(4)
    v_mfma_f32_16x16x32_bf16 v[56:59], v[116:119], v[168:171], v[56:59]
    ds_read_b128 v[96:99], v233 offset:0
    v_mfma_f32_16x16x32_bf16 v[76:79], v[116:119], v[172:175], v[76:79]
    s_waitcnt lgkmcnt(4)
    v_mfma_f32_16x16x32_bf16 v[40:43], v[80:83], v[176:179], v[40:43]
    s_waitcnt vmcnt(6)
    s_barrier
    ds_read_b128 v[100:103], v224 offset:61440
    v_mfma_f32_16x16x32_bf16 v[60:63], v[80:83], v[180:183], v[60:63]
    s_add_u32 m0, s65, 40960
    s_add_u32 s40, s61, 0
    buffer_load_dwordx4 v255, s[16:19], s40 offen offset:0 sc1 lds
    s_waitcnt lgkmcnt(4)
    v_mfma_f32_16x16x32_bf16 v[44:47], v[84:87], v[176:179], v[44:47]
    ds_read_b128 v[104:107], v225 offset:61440
    v_mfma_f32_16x16x32_bf16 v[64:67], v[84:87], v[180:183], v[64:67]
    s_waitcnt lgkmcnt(4)
    v_mfma_f32_16x16x32_bf16 v[48:51], v[88:91], v[176:179], v[48:51]
    ds_read_b128 v[108:111], v226 offset:61440
    buffer_load_dwordx4 v255, s[16:19], s40 offen offset:1024 sc1 lds
    v_mfma_f32_16x16x32_bf16 v[68:71], v[88:91], v[180:183], v[68:71]
    s_waitcnt lgkmcnt(4)
    v_mfma_f32_16x16x32_bf16 v[52:55], v[92:95], v[176:179], v[52:55]
    ds_read_b128 v[112:115], v227 offset:61440
    v_mfma_f32_16x16x32_bf16 v[72:75], v[92:95], v[180:183], v[72:75]
    s_cbranch_vccnz L_pc20
    buffer_load_dwordx4 v255, s[16:19], s40 offen offset:2048 sc1 lds
L_pc20:
    s_waitcnt lgkmcnt(4)
    v_mfma_f32_16x16x32_bf16 v[56:59], v[96:99], v[176:179], v[56:59]
    ds_read_b128 v[116:119], v228 offset:61440
    v_mfma_f32_16x16x32_bf16 v[76:79], v[96:99], v[180:183], v[76:79]
    s_waitcnt lgkmcnt(4)
    v_mfma_f32_16x16x32_bf16 v[40:43], v[100:103], v[184:187], v[40:43]
    ds_read_b128 v[80:83], v224 offset:0
    v_mfma_f32_16x16x32_bf16 v[60:63], v[100:103], v[188:191], v[60:63]
    s_add_u32 m0, s65, 51200
    s_add_u32 s40, s61, 20480
    buffer_load_dwordx4 v255, s[16:19], s40 offen offset:0 sc1 lds
    s_waitcnt lgkmcnt(4)
    v_mfma_f32_16x16x32_bf16 v[44:47], v[104:107], v[184:187], v[44:47]
    ds_read_b128 v[84:87], v225 offset:0
    s_add_u32 s41, s59, 0
    buffer_load_dwordx4 v[0:3], v249, s[16:19], s41 offen offset:0 sc1
    v_mfma_f32_16x16x32_bf16 v[64:67], v[104:107], v[188:191], v[64:67]
    s_waitcnt lgkmcnt(4)
    v_mfma_f32_16x16x32_bf16 v[48:51], v[108:111], v[184:187], v[48:51]
    ds_read_b128 v[88:91], v226 offset:0
    buffer_load_dwordx4 v255, s[16:19], s40 offen offset:1024 sc1 lds
    v_mfma_f32_16x16x32_bf16 v[68:71], v[108:111], v[188:191], v[68:71]
    s_waitcnt lgkmcnt(4)
    v_mfma_f32_16x16x32_bf16 v[52:55], v[112:115], v[184:187], v[52:55]
    ds_read_b128 v[92:95], v227 offset:0
    buffer_load_dwordx4 v[4:7], v240, s[16:19], s41 offen offset:0 sc1
    v_mfma_f32_16x16x32_bf16 v[72:75], v[112:115], v[188:191], v[72:75]
    s_waitcnt lgkmcnt(4)
    v_mfma_f32_16x16x32_bf16 v[56:59], v[116:119], v[184:187], v[56:59]
    ds_read_b128 v[96:99], v228 offset:0
    s_cbranch_vccnz L_pc21
    buffer_load_dwordx4 v255, s[16:19], s40 offen offset:2048 sc1 lds
L_pc21:
    v_mfma_f32_16x16x32_bf16 v[76:79], v[116:119], v[188:191], v[76:79]
    s_waitcnt lgkmcnt(4)
    v_mfma_f32_16x16x32_bf16 v[40:43], v[80:83], v[192:195], v[40:43]
    s_waitcnt vmcnt(8)
    s_barrier
    ds_read_b128 v[100:103], v224 offset:10240
    v_mfma_f32_16x16x32_bf16 v[60:63], v[80:83], v[196:199], v[60:63]
    s_add_u32 s41, s59, 8192
    buffer_load_dwordx4 v[8:11], v249, s[16:19], s41 offen offset:0 sc1
    s_waitcnt lgkmcnt(4)
    v_mfma_f32_16x16x32_bf16 v[44:47], v[84:87], v[192:195], v[44:47]
    ds_read_b128 v[104:107], v225 offset:10240
    v_mfma_f32_16x16x32_bf16 v[64:67], v[84:87], v[196:199], v[64:67]
    s_waitcnt lgkmcnt(4)
    v_mfma_f32_16x16x32_bf16 v[48:51], v[88:91], v[192:195], v[48:51]
    ds_read_b128 v[108:111], v226 offset:10240
    v_mfma_f32_16x16x32_bf16 v[68:71], v[88:91], v[196:199], v[68:71]
    buffer_load_dwordx4 v[12:15], v240, s[16:19], s41 offen offset:0 sc1
    s_waitcnt lgkmcnt(4)
    v_mfma_f32_16x16x32_bf16 v[52:55], v[92:95], v[192:195], v[52:55]
    ds_read_b128 v[112:115], v227 offset:10240
    v_mfma_f32_16x16x32_bf16 v[72:75], v[92:95], v[196:199], v[72:75]
    s_waitcnt lgkmcnt(4)
    v_mfma_f32_16x16x32_bf16 v[56:59], v[96:99], v[192:195], v[56:59]
    ds_read_b128 v[116:119], v228 offset:10240
    v_mfma_f32_16x16x32_bf16 v[76:79], v[96:99], v[196:199], v[76:79]
    s_waitcnt lgkmcnt(4)
    v_mfma_f32_16x16x32_bf16 v[40:43], v[100:103], v[200:203], v[40:43]
    ds_read_b128 v[80:83], v224 offset:20480
    v_mfma_f32_16x16x32_bf16 v[60:63], v[100:103], v[204:207], v[60:63]
    s_add_u32 s41, s59, 16384
    buffer_load_dwordx4 v[16:19], v249, s[16:19], s41 offen offset:0 sc1
    s_waitcnt lgkmcnt(4)
    v_mfma_f32_16x16x32_bf16 v[44:47], v[104:107], v[200:203], v[44:47]
    ds_read_b128 v[84:87], v225 offset:20480
    v_mfma_f32_16x16x32_bf16 v[64:67], v[104:107], v[204:207], v[64:67]
    buffer_load_dwordx4 v[20:23], v240, s[16:19], s41 offen offset:0 sc1
    s_waitcnt lgkmcnt(4)
    v_mfma_f32_16x16x32_bf16 v[48:51], v[108:111], v[200:203], v[48:51]
    ds_read_b128 v[88:91], v226 offset:20480
    v_mfma_f32_16x16x32_bf16 v[68:71], v[108:111], v[204:207], v[68:71]
    s_add_u32 s41, s59, 24576
    buffer_load_dwordx4 v[24:27], v249, s[16:19], s41 offen offset:0 sc1
    s_waitcnt lgkmcnt(4)
    v_mfma_f32_16x16x32_bf16 v[52:55], v[112:115], v[200:203], v[52:55]
    ds_read_b128 v[92:95], v227 offset:20480
    v_mfma_f32_16x16x32_bf16 v[72:75], v[112:115], v[204:207], v[72:75]
    buffer_load_dwordx4 v[28:31], v240, s[16:19], s41 offen offset:0 sc1
    s_waitcnt lgkmcnt(4)
    v_mfma_f32_16x16x32_bf16 v[56:59], v[116:119], v[200:203], v[56:59]
    ds_read_b128 v[96:99], v228 offset:20480
    v_mfma_f32_16x16x32_bf16 v[76:79], v[116:119], v[204:207], v[76:79]
    s_waitcnt lgkmcnt(4)
    v_mfma_f32_16x16x32_bf16 v[40:43], v[80:83], v[208:211], v[40:43]
    s_waitcnt vmcnt(7)
    s_barrier
    ds_read_b128 v[100:103], v224 offset:30720
    v_mfma_f32_16x16x32_bf16 v[60:63], v[80:83], v[212:215], v[60:63]
    buffer_load_dwordx4 v[32:35], v120, s[16:19], s15 offen offset:0 sc1
    s_waitcnt lgkmcnt(4)
    v_mfma_f32_16x16x32_bf16 v[44:47], v[84:87], v[208:211], v[44:47]
    ds_read_b128 v[104:107], v225 offset:30720
    v_mfma_f32_16x16x32_bf16 v[64:67], v[84:87], v[212:215], v[64:67]
    s_waitcnt lgkmcnt(4)
    v_mfma_f32_16x16x32_bf16 v[48:51], v[88:91], v[208:211], v[48:51]
    ds_read_b128 v[108:111], v226 offset:30720
    v_mfma_f32_16x16x32_bf16 v[68:71], v[88:91], v[212:215], v[68:71]
    buffer_load_dwordx4 v[36:39], v120, s[16:19], s15 offen offset:512 sc1
    s_waitcnt lgkmcnt(4)
    v_mfma_f32_16x16x32_bf16 v[52:55], v[92:95], v[208:211], v[52:55]
    ds_read_b128 v[112:115], v227 offset:30720
    v_mfma_f32_16x16x32_bf16 v[72:75], v[92:95], v[212:215], v[72:75]
    s_waitcnt lgkmcnt(4)
    v_mfma_f32_16x16x32_bf16 v[56:59], v[96:99], v[208:211], v[56:59]
    ds_read_b128 v[116:119], v228 offset:30720
    v_mfma_f32_16x16x32_bf16 v[76:79], v[96:99], v[212:215], v[76:79]
    s_waitcnt lgkmcnt(4)
    v_mfma_f32_16x16x32_bf16 v[40:43], v[100:103], v[216:219], v[40:43]
    ds_read_b128 v[80:83], v224 offset:40960
    v_mfma_f32_16x16x32_bf16 v[60:63], v[100:103], v[220:223], v[60:63]
    s_add_u32 m0, s65, 71680
    s_add_u32 s40, s61, 40960
    buffer_load_dwordx4 v255, s[16:19], s40 offen offset:0 sc1 lds
    s_waitcnt lgkmcnt(4)
    v_mfma_f32_16x16x32_bf16 v[44:47], v[104:107], v[216:219], v[44:47]
    ds_read_b128 v[84:87], v225 offset:40960
    s_waitcnt vmcnt(9)
    v_max3_u32 v121, v0, v1, v2
    v_mfma_f32_16x16x32_bf16 v[64:67], v[104:107], v[220:223], v[64:67]
    v_max3_u32 v121, v121, v3, v4
    s_waitcnt lgkmcnt(4)
    v_mfma_f32_16x16x32_bf16 v[48:51], v[108:111], v[216:219], v[48:51]
    ds_read_b128 v[88:91], v226 offset:40960
    buffer_load_dwordx4 v255, s[16:19], s40 offen offset:1024 sc1 lds
    v_max3_u32 v121, v121, v5, v6
    v_mfma_f32_16x16x32_bf16 v[68:71], v[108:111], v[220:223], v[68:71]
    v_max3_u32 v121, v121, v7, v7
    s_waitcnt lgkmcnt(4)
    v_mfma_f32_16x16x32_bf16 v[52:55], v[112:115], v[216:219], v[52:55]
    ds_read_b128 v[92:95], v227 offset:40960
    v_mfma_f32_16x16x32_bf16 v[72:75], v[112:115], v[220:223], v[72:75]
    s_cbranch_vccnz L_pc22
    buffer_load_dwordx4 v255, s[16:19], s40 offen offset:2048 sc1 lds
L_pc22:
    s_waitcnt lgkmcnt(4)
    v_mfma_f32_16x16x32_bf16 v[56:59], v[116:119], v[216:219], v[56:59]
    ds_read_b128 v[96:99], v228 offset:40960
    v_mfma_f32_16x16x32_bf16 v[76:79], v[116:119], v[220:223], v[76:79]
    v_cmp_eq_u32 vcc, -1, v121
    s_nop 0
    s_cbranch_vccnz L_or11
L_or11_ret:
    s_cmp_eq_u32 s27, 0
    s_cselect_b64 vcc, 0, -1
    v_mul_f32 v40, v40, v122
    v_mul_f32 v41, v41, v122
    v_mul_f32 v42, v42, v122
    v_mul_f32 v43, v43, v122
    v_mul_f32 v60, v60, v123
    v_mul_f32 v61, v61, v123
    v_mul_f32 v62, v62, v123
    v_mul_f32 v63, v63, v123
    s_waitcnt lgkmcnt(4)
    v_mfma_f32_16x16x32_bf16 v[40:43], v[80:83], v[0:3], v[40:43]
    ds_read_b128 v[100:103], v224 offset:51200
    v_mul_f32 v44, v44, v122
    v_mul_f32 v45, v45, v122
    v_mul_f32 v46, v46, v122
    v_mul_f32 v47, v47, v122
    v_mfma_f32_16x16x32_bf16 v[60:63], v[80:83], v[4:7], v[60:63]
    s_add_u32 m0, s65, 61440
    s_add_u32 s40, s61, 61440
    buffer_load_dwordx4 v255, s[16:19], s40 offen offset:0 sc1 lds
    v_mul_f32 v64, v64, v123
    v_mul_f32 v65, v65, v123
    v_mul_f32 v66, v66, v123
    v_mul_f32 v67, v67, v123
    s_waitcnt lgkmcnt(4)
    v_mfma_f32_16x16x32_bf16 v[44:47], v[84:87], v[0:3], v[44:47]
    ds_read_b128 v[104:107], v225 offset:51200
    buffer_load_dwordx4 v255, s[16:19], s40 offen offset:1024 sc1 lds
    s_waitcnt vmcnt(10)
    v_max3_u32 v121, v8, v9, v10
    v_mul_f32 v48, v48, v122
    v_mul_f32 v49, v49, v122
    v_mul_f32 v50, v50, v122
    v_mul_f32 v51, v51, v122
    v_mfma_f32_16x16x32_bf16 v[64:67], v[84:87], v[4:7], v[64:67]
    v_max3_u32 v121, v121, v11, v12
    v_mul_f32 v68, v68, v123
    v_mul_f32 v69, v69, v123
    v_mul_f32 v70, v70, v123
    v_mul_f32 v71, v71, v123
    s_waitcnt lgkmcnt(4)
    v_mfma_f32_16x16x32_bf16 v[48:51], v[88:91], v[0:3], v[48:51]
    ds_read_b128 v[108:111], v226 offset:51200
    s_cbranch_vccnz L_pc23
    buffer_load_dwordx4 v255, s[16:19], s40 offen offset:2048 sc1 lds
L_pc23:
    v_max3_u32 v121, v121, v13, v14
    v_mul_f32 v52, v52, v122
    v_mul_f32 v53, v53, v122
    v_mul_f32 v54, v54, v122
    v_mul_f32 v55, v55, v122
    v_mfma_f32_16x16x32_bf16 v[68:71], v[88:91], v[4:7], v[68:71]
    s_add_u32 m0, s65, 0
    s_add_u32 s40, s61, 81920
    buffer_load_dwordx4 v255, s[16:19], s40 offen offset:0 sc1 lds
    v_max3_u32 v121, v121, v15, v15
    v_mul_f32 v72, v72, v123
    v_mul_f32 v73, v73, v123
    v_mul_f32 v74, v74, v123
    v_mul_f32 v75, v75, v123
    s_waitcnt lgkmcnt(4)
    v_mfma_f32_16x16x32_bf16 v[52:55], v[92:95], v[0:3], v[52:55]
    ds_read_b128 v[112:115], v227 offset:51200
    v_mul_f32 v56, v56, v122
    v_mul_f32 v57, v57, v122
    v_mul_f32 v58, v58, v122
    v_mul_f32 v59, v59, v122
    v_mfma_f32_16x16x32_bf16 v[72:75], v[92:95], v[4:7], v[72:75]
    buffer_load_dwordx4 v255, s[16:19], s40 offen offset:1024 sc1 lds
    v_mul_f32 v76, v76, v123
    v_mul_f32 v77, v77, v123
    v_mul_f32 v78, v78, v123
    v_mul_f32 v79, v79, v123
    s_waitcnt lgkmcnt(4)
    v_mfma_f32_16x16x32_bf16 v[56:59], v[96:99], v[0:3], v[56:59]
    ds_read_b128 v[116:119], v228 offset:51200
    s_cbranch_vccnz L_pc24
    buffer_load_dwordx4 v255, s[16:19], s40 offen offset:2048 sc1 lds
L_pc24:
    v_mfma_f32_16x16x32_bf16 v[76:79], v[96:99], v[4:7], v[76:79]
    v_cmp_eq_u32 vcc, -1, v121
    s_nop 0
    s_cbranch_vccnz L_or12
L_or12_ret:
    s_waitcnt lgkmcnt(4)
    v_mfma_f32_16x16x32_bf16 v[40:43], v[100:103], v[8:11], v[40:43]
    s_waitcnt vmcnt(4)
    s_barrier
    ds_read_b128 v[80:83], v229 offset:0
    v_mfma_f32_16x16x32_bf16 v[60:63], v[100:103], v[12:15], v[60:63]
    s_waitcnt lgkmcnt(4)
    v_mfma_f32_16x16x32_bf16 v[44:47], v[104:107], v[8:11], v[44:47]
    ds_read_b128 v[84:87], v230 offset:0
    s_waitcnt vmcnt(10)
    v_max3_u32 v121, v16, v17, v18
    v_mfma_f32_16x16x32_bf16 v[64:67], v[104:107], v[12:15], v[64:67]
    v_max3_u32 v121, v121, v19, v20
    s_waitcnt lgkmcnt(4)
    v_mfma_f32_16x16x32_bf16 v[48:51], v[108:111], v[8:11], v[48:51]
    ds_read_b128 v[88:91], v231 offset:0
    v_max3_u32 v121, v121, v21, v22
    v_mfma_f32_16x16x32_bf16 v[68:71], v[108:111], v[12:15], v[68:71]
    v_max3_u32 v121, v121, v23, v23
    s_waitcnt lgkmcnt(4)
    v_mfma_f32_16x16x32_bf16 v[52:55], v[112:115], v[8:11], v[52:55]
    ds_read_b128 v[92:95], v232 offset:0
    v_mfma_f32_16x16x32_bf16 v[72:75], v[112:115], v[12:15], v[72:75]
    s_waitcnt lgkmcnt(4)
    v_mfma_f32_16x16x32_bf16 v[56:59], v[116:119], v[8:11], v[56:59]
    ds_read_b128 v[96:99], v233 offset:0
    v_mfma_f32_16x16x32_bf16 v[76:79], v[116:119], v[12:15], v[76:79]
    v_cmp_eq_u32 vcc, -1, v121
    s_nop 0
    s_cbranch_vccnz L_or13
L_or13_ret:
    s_waitcnt lgkmcnt(4)
    v_mfma_f32_16x16x32_bf16 v[40:43], v[80:83], v[16:19], v[40:43]
    s_waitcnt vmcnt(0)
    s_barrier
    ds_read_b128 v[100:103], v225 offset:61440
    v_mfma_f32_16x16x32_bf16 v[60:63], v[80:83], v[20:23], v[60:63]
    s_waitcnt lgkmcnt(4)
    v_mfma_f32_16x16x32_bf16 v[44:47], v[84:87], v[16:19], v[44:47]
    ds_read_b128 v[104:107], v225 offset:0
    s_waitcnt vmcnt(6)
    v_max3_u32 v121, v24, v25, v26
    v_mfma_f32_16x16x32_bf16 v[64:67], v[84:87], v[20:23], v[64:67]
    v_max3_u32 v121, v121, v27, v28
    s_waitcnt lgkmcnt(4)
    v_mfma_f32_16x16x32_bf16 v[48:51], v[88:91], v[16:19], v[48:51]
    ds_read_b128 v[108:111], v226 offset:61440
    v_max3_u32 v121, v121, v29, v30
    v_mfma_f32_16x16x32_bf16 v[68:71], v[88:91], v[20:23], v[68:71]
    v_max3_u32 v121, v121, v31, v32
    s_waitcnt lgkmcnt(4)
    v_mfma_f32_16x16x32_bf16 v[52:55], v[92:95], v[16:19], v[52:55]
    ds_read_b128 v[112:115], v226 offset:0
    v_max3_u32 v121, v121, v33, v34
    v_mfma_f32_16x16x32_bf16 v[72:75], v[92:95], v[20:23], v[72:75]
    v_max3_u32 v121, v121, v35, v36
    s_waitcnt lgkmcnt(4)
    v_mfma_f32_16x16x32_bf16 v[56:59], v[96:99], v[16:19], v[56:59]
    ds_read_b128 v[116:119], v227 offset:61440
    v_max3_u32 v121, v121, v37, v38
    v_mfma_f32_16x16x32_bf16 v[76:79], v[96:99], v[20:23], v[76:79]
    v_max3_u32 v121, v121, v39, v39
    v_cmp_eq_u32 vcc, -1, v121
    s_nop 0
    s_cbranch_vccnz L_or14
L_or14_ret:
    v_swap_b32 v34, v36
    v_swap_b32 v35, v37
    s_waitcnt lgkmcnt(4)
    v_mfma_f32_16x16x32_bf16 v[44:47], v[100:103], v[24:27], v[44:47]
    ds_read_b128 v[80:83], v227 offset:0
    v_mfma_f32_16x16x32_bf16 v[64:67], v[100:103], v[28:31], v[64:67]
    s_waitcnt lgkmcnt(4)
    v_mfma_f32_16x16x32_bf16 v[44:47], v[104:107], v[32:35], v[44:47]
    ds_read_b128 v[84:87], v228 offset:61440
    v_mfma_f32_16x16x32_bf16 v[64:67], v[104:107], v[36:39], v[64:67]
    s_waitcnt lgkmcnt(4)
    v_mfma_f32_16x16x32_bf16 v[48:51], v[108:111], v[24:27], v[48:51]
    ds_read_b128 v[88:91], v228 offset:0
    v_mfma_f32_16x16x32_bf16 v[68:71], v[108:111], v[28:31], v[68:71]
    s_waitcnt lgkmcnt(4)
    v_mfma_f32_16x16x32_bf16 v[48:51], v[112:115], v[32:35], v[48:51]
    ds_read_b128 v[92:95], v224 offset:61440
    ds_write_b128 v235, v[44:47] offset:0
    v_mfma_f32_16x16x32_bf16 v[68:71], v[112:115], v[36:39], v[68:71]
    ds_write_b128 v235, v[64:67] offset:3072
    s_waitcnt lgkmcnt(4)
    v_mfma_f32_16x16x32_bf16 v[52:55], v[116:119], v[24:27], v[52:55]
    ds_read_b128 v[96:99], v224 offset:0
    v_mfma_f32_16x16x32_bf16 v[72:75], v[116:119], v[28:31], v[72:75]
    s_waitcnt lgkmcnt(4)
    v_mfma_f32_16x16x32_bf16 v[52:55], v[80:83], v[32:35], v[52:55]
    ds_write_b128 v236, v[48:51] offset:1024
    v_mfma_f32_16x16x32_bf16 v[72:75], v[80:83], v[36:39], v[72:75]
    ds_write_b128 v236, v[68:71] offset:4096
    s_waitcnt lgkmcnt(3)
    v_mfma_f32_16x16x32_bf16 v[56:59], v[84:87], v[24:27], v[56:59]
    v_mfma_f32_16x16x32_bf16 v[76:79], v[84:87], v[28:31], v[76:79]
    s_waitcnt lgkmcnt(2)
    v_mfma_f32_16x16x32_bf16 v[56:59], v[88:91], v[32:35], v[56:59]
    ds_write_b128 v237, v[52:55] offset:2048
    v_mfma_f32_16x16x32_bf16 v[76:79], v[88:91], v[36:39], v[76:79]
    ds_write_b128 v237, v[72:75] offset:5120
    s_waitcnt lgkmcnt(1)
    v_mfma_f32_16x16x32_bf16 v[40:43], v[92:95], v[24:27], v[40:43]
    v_mfma_f32_16x16x32_bf16 v[60:63], v[92:95], v[28:31], v[60:63]
    s_waitcnt lgkmcnt(0)
    v_mfma_f32_16x16x32_bf16 v[40:43], v[96:99], v[32:35], v[40:43]
    v_mfma_f32_16x16x32_bf16 v[60:63], v[96:99], v[36:39], v[60:63]
    ds_write_b128 v238, v[56:59] offset:0
    ds_write_b128 v238, v[76:79] offset:4096
    s_lshl_b32 s31, s12, 5
    s_add_u32 s31, s31, s63
    s_waitcnt lgkmcnt(0)
    s_barrier
    ds_read_b128 v[128:131], v239 offset:0
    ds_read_b128 v[132:135], v239 offset:1024
    ds_read_b128 v[136:139], v239 offset:2048
    ds_read_b128 v[140:143], v239 offset:3072
    ds_read_b128 v[144:147], v239 offset:4096
    ds_read_b128 v[148:151], v239 offset:5120
    s_cmp_lt_u32 s12, 2
    s_cbranch_scc0 L_p5_a
    s_lshl_b32 s13, s12, 12
    v_add_u32 v234, s13, v234
    s_mul_i32 s13, s12, 40960
    s_add_u32 s13, s13, s63
    ds_read_b128 v[152:155], v234 offset:24576
    ds_read_b128 v[156:159], v234 offset:25600
    ds_read_b128 v[160:163], v234 offset:26624
    ds_read_b128 v[164:167], v234 offset:27648
L_p5_a:
    s_waitcnt lgkmcnt(3)
    v_pk_add_f32 v[128:129], v[128:129], v[132:133]
    v_pk_add_f32 v[130:131], v[130:131], v[134:135]
    v_pk_add_f32 v[40:41], v[40:41], v[136:137]
    v_pk_add_f32 v[42:43], v[42:43], v[138:139]
    v_pk_add_f32 v[40:41], v[40:41], v[128:129]
    v_pk_add_f32 v[42:43], v[42:43], v[130:131]
    v_cvt_pk_bf16_f32 v0, v40, v41
    v_cvt_pk_bf16_f32 v1, v42, v43
    s_waitcnt lgkmcnt(0)
    v_pk_add_f32 v[140:141], v[140:141], v[144:145]
    v_pk_add_f32 v[142:143], v[142:143], v[146:147]
    v_pk_add_f32 v[60:61], v[60:61], v[148:149]
    v_pk_add_f32 v[62:63], v[62:63], v[150:151]
    v_pk_add_f32 v[60:61], v[60:61], v[140:141]
    v_pk_add_f32 v[62:63], v[62:63], v[142:143]
    v_cvt_pk_bf16_f32 v2, v60, v61
    v_cvt_pk_bf16_f32 v3, v62, v63
    s_nop 1
    v_permlane16_swap_b32 v0, v2
    v_permlane16_swap_b32 v1, v3
    buffer_store_dwordx4 v[0:3], v126, s[20:23], s31 offen
    s_cmp_lt_u32 s12, 2
    s_cbranch_scc0 L_p5_end
    v_pk_add_f32 v[152:153], v[152:153], v[156:157]
    v_pk_add_f32 v[154:155], v[154:155], v[158:159]
    v_pk_add_f32 v[160:161], v[160:161], v[164:165]
    v_pk_add_f32 v[162:163], v[162:163], v[166:167]
    v_pk_add_f32 v[152:153], v[152:153], v[160:161]
    v_pk_add_f32 v[154:155], v[154:155], v[162:163]
    v_cvt_pk_bf16_f32 v152, v152, v153
    v_cvt_pk_bf16_f32 v153, v154, v155
    buffer_store_dwordx2 v[152:153], v127, s[20:23], s13 offen offset:128
L_p5_end:
L_end:
    s_endpgm
L_at_z1:
    ds_write_b128 v104, v[64:67] offset:0
    ds_write_b128 v104, v[68:71] offset:1024
    ds_write_b128 v106, v[72:75] offset:0
    v_mov_b32 v64, v80
    v_mov_b32 v65, v81
    v_mov_b32 v66, v82
    v_mov_b32 v67, v83
    v_mov_b32 v68, v84
    v_mov_b32 v69, v85
    v_mov_b32 v70, v86
    v_mov_b32 v71, v87
    v_mov_b32 v72, v88
    v_mov_b32 v73, v89
    v_mov_b32 v74, v90
    v_mov_b32 v75, v91
    s_branch L_at_zj
L_p2_1:
    ds_read_b64_tr_b16 v[192:193], v212 offset:32768
    ds_read_b64_tr_b16 v[194:195], v212 offset:33792
    ds_read_b64_tr_b16 v[200:201], v212 offset:36864
    ds_read_b64_tr_b16 v[202:203], v212 offset:37888
    s_mov_b64 s[4:5], s[46:47]
    s_mov_b32 s6, 1966080
    s_mov_b64 s[8:9], s[48:49]
    s_mov_b32 s10, 819200
    s_waitcnt lgkmcnt(2)
    v_mfma_f32_32x32x16_bf16 v[160:175], v[192:195], v[0:3], 0
    ds_read_b64_tr_b16 v[228:229], v212 offset:40960
    ds_read_b64_tr_b16 v[230:231], v212 offset:41984
    s_mov_b32 s99, s30
    v_add_u32 v218, 12288, v219
    s_mov_b64 s[88:89], s[12:13]
    s_mov_b64 s[90:91], s[14:15]
    s_mul_i32 s92, s27, 196608
    s_add_u32 s27, s27, 1
    s_cmp_eq_u32 s27, 10
    s_cselect_b32 s27, 0, s27
    s_mul_i32 s93, s27, 196608
    s_add_u32 s27, s27, 1
    s_cmp_eq_u32 s27, 10
    s_cselect_b32 s27, 0, s27
    s_mul_i32 s94, s27, 196608
    s_add_u32 s27, s27, 1
    s_cmp_eq_u32 s27, 10
    s_cselect_b32 s27, 0, s27
    s_mul_i32 s95, s27, 196608
    s_add_u32 s27, s27, 1
    s_cmp_eq_u32 s27, 10
    s_cselect_b32 s27, 0, s27
    s_mul_i32 s96, s27, 196608
    s_add_u32 s27, s27, 1
    s_cmp_eq_u32 s27, 10
    s_cselect_b32 s27, 0, s27
    s_mul_i32 s97, s27, 196608
    s_add_u32 s27, s27, 1
    s_cmp_eq_u32 s27, 10
    s_cselect_b32 s27, 0, s27
    s_waitcnt lgkmcnt(2)
    v_mfma_f32_32x32x16_bf16 v[160:175], v[200:203], v[4:7], v[160:175]
    ds_read_b64_tr_b16 v[192:193], v212 offset:45056
    ds_read_b64_tr_b16 v[194:195], v212 offset:46080
    s_waitcnt lgkmcnt(2)
    v_mfma_f32_32x32x16_bf16 v[160:175], v[228:231], v[8:11], v[160:175]
    ds_read_b64_tr_b16 v[200:201], v214 offset:32768
    ds_read_b64_tr_b16 v[202:203], v214 offset:33792
    s_add_u32 m0, s99, 65536
    s_nop 0
    buffer_load_dwordx4 v219, s[88:91], s92 offen lds
    s_waitcnt lgkmcnt(2)
    v_mfma_f32_32x32x16_bf16 v[160:175], v[192:195], v[12:15], v[160:175]
    ds_read_b64_tr_b16 v[228:229], v214 offset:36864
    ds_read_b64_tr_b16 v[230:231], v214 offset:37888
    s_add_u32 m0, s99, 66560
    s_nop 0
    buffer_load_dwordx4 v218, s[88:91], s92 offen lds
    s_waitcnt lgkmcnt(2)
    v_mfma_f32_32x32x16_bf16 v[160:175], v[200:203], v[16:19], v[160:175]
    ds_read_b64_tr_b16 v[192:193], v214 offset:40960
    ds_read_b64_tr_b16 v[194:195], v214 offset:41984
    s_add_u32 m0, s99, 0
    s_nop 0
    buffer_load_dwordx4 v219, s[88:91], s93 offen lds
    s_waitcnt lgkmcnt(2)
    v_mfma_f32_32x32x16_bf16 v[160:175], v[228:231], v[20:23], v[160:175]
    ds_read_b64_tr_b16 v[200:201], v214 offset:45056
    ds_read_b64_tr_b16 v[202:203], v214 offset:46080
    s_waitcnt lgkmcnt(2)
    v_mfma_f32_32x32x16_bf16 v[160:175], v[192:195], v[24:27], v[160:175]
    s_waitcnt vmcnt(7) lgkmcnt(0)
    s_barrier
    ds_read_b64_tr_b16 v[228:229], v212 offset:49152
    ds_read_b64_tr_b16 v[230:231], v212 offset:50176
    s_add_u32 m0, s99, 1024
    s_nop 0
    buffer_load_dwordx4 v218, s[88:91], s93 offen lds
    s_waitcnt lgkmcnt(2)
    v_mfma_f32_32x32x16_bf16 v[160:175], v[200:203], v[28:31], v[160:175]
    ds_read_b64_tr_b16 v[192:193], v212 offset:53248
    ds_read_b64_tr_b16 v[194:195], v212 offset:54272
    s_add_u32 m0, s99, 81920
    s_nop 0
    buffer_load_dwordx4 v219, s[88:91], s94 offen lds
    v_lshlrev_b32 v255, 4, v236
    v_and_b32 v12, 0x1ff, v255
    s_lshl_b32 s31, s25, 2
    s_add_u32 s31, s31, s35
    s_mul_i32 s31, s31, 98304
    s_mul_i32 s32, s26, 3
    s_lshl_b32 s33, s34, 1
    s_add_u32 s32, s32, s33
    s_waitcnt lgkmcnt(2)
    v_mfma_f32_32x32x16_bf16 v[160:175], v[228:231], v[32:35], v[160:175]
    ds_read_b64_tr_b16 v[200:201], v212 offset:57344
    ds_read_b64_tr_b16 v[202:203], v212 offset:58368
    s_add_u32 m0, s99, 82944
    s_nop 0
    buffer_load_dwordx4 v218, s[88:91], s94 offen lds
    s_lshl_b32 s32, s32, 11
    s_add_u32 s31, s31, s32
    s_add_u32 s43, s31, 7864320
    s_lshl_b32 s39, s25, 7
    s_lshl_b32 s40, s26, 3
    s_add_u32 s39, s39, s40
    s_add_u32 s39, s39, 16818176
    s_cmp_eq_u32 s24, 0
    s_waitcnt lgkmcnt(2)
    v_mfma_f32_32x32x16_bf16 v[160:175], v[192:195], v[36:39], v[160:175]
    ds_read_b64_tr_b16 v[228:229], v212 offset:61440
    ds_read_b64_tr_b16 v[230:231], v212 offset:62464
    s_cselect_b32 s66, s39, 0x80000000
    s_add_u32 m0, s99, 16384
    s_nop 0
    buffer_load_dwordx4 v219, s[88:91], s95 offen lds
    s_lshl_b32 s39, s26, 7
    s_lshl_b32 s40, s25, 3
    s_add_u32 s39, s39, s40
    s_add_u32 s39, s39, 16785408
    s_cmp_eq_u32 s24, 4
    s_cselect_b32 s42, s39, 0x80000000
    s_mov_b32 s27, s34
    s_mov_b32 s28, s35
    s_waitcnt lgkmcnt(2)
    v_mfma_f32_32x32x16_bf16 v[160:175], v[200:203], v[40:43], v[160:175]
    ds_read_b64_tr_b16 v[192:193], v214 offset:49152
    ds_read_b64_tr_b16 v[194:195], v214 offset:50176
    s_mul_i32 s0, s27, 81920
    s_and_b32 s3, s24, 1
    s_sub_u32 s32, 3, s27
    s_mul_i32 s32, s32, s3
    s_mul_i32 s33, s27, 6
    s_add_u32 s12, s32, s33
    s_bfe_u32 s13, s24, 0x10001
    s_mul_i32 s32, s13, 81920
    s_waitcnt lgkmcnt(2)
    v_mfma_f32_32x32x16_bf16 v[160:175], v[228:231], v[44:47], v[160:175]
    ds_read_b64_tr_b16 v[200:201], v214 offset:53248
    ds_read_b64_tr_b16 v[202:203], v214 offset:54272
    s_add_u32 m0, s99, 17408
    s_nop 0
    buffer_load_dwordx4 v218, s[88:91], s95 offen lds
    s_lshl_b32 s12, s12, 10
    s_add_u32 s65, s32, s12
    s_mul_i32 s35, s3, 5120
    s_add_u32 s35, s35, s32
    s_mul_i32 s32, s13, 10240
    s_add_u32 s12, s12, s32
    s_and_b32 s31, s2, 7
    s_lshr_b32 s33, s2, 6
    s_waitcnt lgkmcnt(2)
    v_mfma_f32_32x32x16_bf16 v[160:175], v[192:195], v[48:51], v[160:175]
    s_waitcnt vmcnt(8)
    s_barrier
    ds_read_b64_tr_b16 v[228:229], v214 offset:57344
    ds_read_b64_tr_b16 v[230:231], v214 offset:58368
    s_add_u32 m0, s99, 98304
    s_nop 0
    buffer_load_dwordx4 v219, s[88:91], s96 offen lds
    v_mov_b32 v10, s42
    v_mov_b32 v8, s44
    v_mov_b32 v9, s45
    s_mov_b64 exec, 1
    buffer_store_dwordx2 v[8:9], v10, s[16:19], 0 offen sc1
    s_mov_b64 exec, -1
    s_bfe_u32 s26, s2, 0x30003
    s_lshl_b32 s25, s31, 2
    s_add_u32 s25, s25, s33
    s_mov_b32 s48, 0x11111111
    s_lshl_b32 s49, 0x101, s26
    s_lshl_b32 s39, s26, 8
    s_lshl_b32 s40, s25, 3
    s_add_u32 s39, s39, s40
    s_waitcnt lgkmcnt(2)
    v_mfma_f32_32x32x16_bf16 v[160:175], v[200:203], v[52:55], v[160:175]
    ds_read_b64_tr_b16 v[192:193], v214 offset:61440
    ds_read_b64_tr_b16 v[194:195], v214 offset:62464
    s_add_u32 m0, s99, 99328
    s_nop 0
    buffer_load_dwordx4 v218, s[88:91], s96 offen lds
    s_add_u32 s39, s39, 16850944
    s_cmp_eq_u32 s24, 0
    s_cselect_b32 s67, s39, 0x80000000
    v_lshrrev_b32 v0, 4, v236
    v_add_u32 v0, 1, v0
    v_mul_u32_u24 v1, 640, v0
    v_cmp_eq_u32 vcc, 3, v0
    s_mul_i32 s39, s25, 20
    s_waitcnt lgkmcnt(2)
    v_mfma_f32_32x32x16_bf16 v[160:175], v[228:231], v[56:59], v[160:175]
    s_waitcnt vmcnt(7)
    s_barrier
    ds_read_b64_tr_b16 v[200:201], v212 offset:0
    ds_read_b64_tr_b16 v[202:203], v212 offset:1024
    s_add_u32 m0, s99, 32768
    s_nop 0
    buffer_load_dwordx4 v219, s[88:91], s97 offen lds
    v_bfe_u32 v3, v236, 3, 1
    v_cndmask_b32 v1, v1, 0, vcc
    v_mul_u32_u24 v3, 19, v3
    v_add3_u32 v1, v1, v3, s39
    v_min_u32 v1, 1919, v1
    v_lshrrev_b32 v1, 5, v1
    v_lshrrev_b32 v3, 2, v1
    v_subrev_u32 v4, 12, v1
    s_waitcnt lgkmcnt(2)
    v_mfma_f32_32x32x16_bf16 v[160:175], v[192:195], v[60:63], v[160:175]
    ds_read_b64_tr_b16 v[228:229], v212 offset:4096
    ds_read_b64_tr_b16 v[230:231], v212 offset:5120
    v_mul_u32_u24 v4, 43, v4
    v_lshrrev_b32 v4, 7, v4
    v_cmp_le_u32 vcc, 48, v1
    v_and_b32 v0, 7, v236
    v_lshlrev_b32 v0, 4, v0
    v_cndmask_b32 v3, v3, v4, vcc
    v_lshl_add_u32 v3, v3, 7, v0
    v_add_u32 v254, 16785408, v3
    s_waitcnt lgkmcnt(2)
    v_mfma_f32_32x32x16_bf16 v[160:175], v[200:203], v[64:67], v[160:175]
    ds_read_b64_tr_b16 v[192:193], v212 offset:8192
    ds_read_b64_tr_b16 v[194:195], v212 offset:9216
    s_add_u32 m0, s99, 33792
    s_nop 0
    buffer_load_dwordx4 v218, s[88:91], s97 offen lds
    s_lshr_b32 s39, s31, 1
    s_lshl_b32 s39, s39, 3
    s_add_u32 s39, s39, s26
    s_and_b32 s40, s31, 1
    s_lshl_b32 s40, s40, 2
    s_add_u32 s40, s40, s33
    s_mul_i32 s36, s26, 3
    s_lshr_b32 s36, s36, 1
    s_waitcnt lgkmcnt(2)
    v_mfma_f32_32x32x16_bf16 v[160:175], v[228:231], v[68:71], v[160:175]
    ds_read_b64_tr_b16 v[200:201], v212 offset:12288
    ds_read_b64_tr_b16 v[202:203], v212 offset:13312
    s_lshl_b32 m0, s24, 10
    s_add_u32 m0, m0, 151552
    s_nop 0
    buffer_load_dwordx4 v253, s[8:11], 0 offen lds
    s_mul_i32 s33, s33, 3
    s_add_u32 s36, s36, s33
    s_cmp_ge_u32 s36, 12
    s_cselect_b32 s33, 12, 0
    s_sub_u32 s36, s36, s33
    s_lshr_b32 s33, s24, 1
    s_lshl_b32 s31, s33, 11
    s_mul_i32 s58, s39, 196608
    s_waitcnt lgkmcnt(2)
    v_mfma_f32_32x32x16_bf16 v[160:175], v[192:195], v[72:75], v[160:175]
    ds_read_b64_tr_b16 v[228:229], v214 offset:0
    ds_read_b64_tr_b16 v[230:231], v214 offset:1024
    s_lshl_b32 m0, s24, 10
    s_add_u32 m0, m0, 143360
    s_nop 0
    buffer_load_dwordx4 v252, s[4:7], 0 offen lds
    s_add_u32 s58, s58, s31
    s_add_u32 s58, s58, 7864320
    s_add_u32 s62, s58, 98304
    s_lshl_b32 s57, s36, 13
    s_add_u32 s57, s57, s58
    s_lshl_b32 s59, s39, 16
    s_add_u32 s59, s59, s31
    s_add_u32 s59, s59, 14155776
    s_waitcnt lgkmcnt(2)
    v_mfma_f32_32x32x16_bf16 v[160:175], v[200:203], v[76:79], v[160:175]
    ds_read_b64_tr_b16 v[192:193], v214 offset:4096
    ds_read_b64_tr_b16 v[194:195], v214 offset:5120
    s_lshl_b32 s15, s39, 2
    s_add_u32 s15, s15, s33
    s_lshl_b32 s15, s15, 12
    s_add_u32 s15, s15, 16252928
    s_lshl_b32 s31, s39, 2
    s_add_u32 s31, s31, s3
    s_lshl_b32 s64, s31, 6
    s_add_u32 s64, s64, 16777216
    s_waitcnt lgkmcnt(2)
    v_mfma_f32_32x32x16_bf16 v[160:175], v[228:231], v[80:83], v[160:175]
    ds_read_b64_tr_b16 v[200:201], v214 offset:8192
    ds_read_b64_tr_b16 v[202:203], v214 offset:9216
    s_mul_i32 s63, s31, 20480
    s_mul_i32 s41, s40, 160
    s_add_u32 s63, s63, s41
    s_mul_i32 s1, s40, 348160
    s_add_u32 s1, s1, 18874368
    s_add_u32 s60, s1, s12
    s_add_u32 s61, s60, 245760
    s_mul_i32 s56, s36, 20480
    s_waitcnt lgkmcnt(2)
    v_mfma_f32_32x32x16_bf16 v[160:175], v[192:195], v[84:87], v[160:175]
    ds_read_b64_tr_b16 v[228:229], v214 offset:12288
    ds_read_b64_tr_b16 v[230:231], v214 offset:13312
    s_add_u32 s56, s56, s60
    s_lshl_b32 s31, s24, 6
    v_add_u32 v0, s31, v236
    v_mov_b32 v5, 0x80000000
    v_mul_u32_u24 v1, 205, v0
    v_lshrrev_b32 v1, 15, v1
    v_lshrrev_b32 v2, 5, v0
    v_bfe_u32 v3, v236, 2, 3
    s_waitcnt lgkmcnt(2)
    v_mfma_f32_32x32x16_bf16 v[160:175], v[200:203], v[88:91], v[160:175]
    s_waitcnt vmcnt(7)
    s_barrier
    ds_read_b64_tr_b16 v[192:193], v212 offset:16384
    ds_read_b64_tr_b16 v[194:195], v212 offset:17408
    v_mul_u32_u24 v3, 160, v3
    v_and_b32 v4, 3, v236
    v_lshl_add_u32 v3, v4, 3, v3
    v_lshl_add_u32 v4, v2, 5, v3
    v_add_u32 v241, 151552, v4
    v_mul_u32_u24 v6, 2400, v1
    v_add_u32 v4, 143360, v4
    v_add_u32 v240, v4, v6
    s_waitcnt lgkmcnt(2)
    v_mfma_f32_32x32x16_bf16 v[160:175], v[228:231], v[92:95], v[160:175]
    ds_read_b64_tr_b16 v[200:201], v212 offset:20480
    ds_read_b64_tr_b16 v[202:203], v212 offset:21504
    v_and_b32 v4, 0x1ff, v255
    v_lshl_add_u32 v2, v2, 10, v4
    s_mul_i32 s32, s39, 3
    v_add_u32 v4, s32, v1
    v_lshrrev_b32 v6, 1, v4
    v_sub_u32 v6, v6, v1
    v_mul_u32_u24 v6, 5120, v6
    v_and_b32 v4, 1, v4
    s_waitcnt lgkmcnt(2)
    v_mfma_f32_32x32x16_bf16 v[160:175], v[192:195], v[96:99], v[160:175]
    ds_read_b64_tr_b16 v[228:229], v212 offset:24576
    ds_read_b64_tr_b16 v[230:231], v212 offset:25600
    v_lshl_add_u32 v4, v4, 9, v2
    v_cmp_gt_u32 vcc, 480, v0
    v_add3_u32 v4, v4, v6, s1
    s_add_u32 s1, s1, 245760
    v_cndmask_b32 v242, v5, v4, vcc
    s_lshr_b32 s32, s39, 1
    s_mul_i32 s32, s32, 5120
    s_and_b32 s33, s39, 1
    s_waitcnt lgkmcnt(2)
    v_mfma_f32_32x32x16_bf16 v[160:175], v[200:203], v[100:103], v[160:175]
    ds_read_b64_tr_b16 v[192:193], v212 offset:28672
    ds_read_b64_tr_b16 v[194:195], v212 offset:29696
    s_lshl_b32 s33, s33, 9
    s_add_u32 s32, s32, s33
    s_add_u32 s32, s32, s1
    v_add_u32 v2, s32, v2
    s_lshr_b32 s32, s39, 3
    s_mul_i32 s32, s32, 5120
    s_bfe_u32 s33, s39, 0x20001
    s_lshl_b32 s33, s33, 8
    s_waitcnt lgkmcnt(2)
    v_mfma_f32_32x32x16_bf16 v[160:175], v[228:231], v[104:107], v[160:175]
    ds_read_b64_tr_b16 v[200:201], v214 offset:16384
    ds_read_b64_tr_b16 v[202:203], v214 offset:17408
    s_add_u32 s32, s32, s33
    s_add_u32 s32, s32, 71680
    s_add_u32 s32, s32, s1
    v_lshrrev_b32 v1, 4, v0
    v_and_b32 v4, 0xff, v255
    v_lshl_add_u32 v4, v1, 10, v4
    v_add_u32 v4, s32, v4
    v_bfe_u32 v6, v236, 4, 1
    s_waitcnt lgkmcnt(2)
    v_mfma_f32_32x32x16_bf16 v[160:175], v[192:195], v[108:111], v[160:175]
    ds_read_b64_tr_b16 v[228:229], v214 offset:20480
    ds_read_b64_tr_b16 v[230:231], v214 offset:21504
    v_mul_u32_u24 v6, 640, v6
    v_sub_u32 v3, v3, v6
    v_lshl_add_u32 v3, v1, 5, v3
    v_cmp_gt_u32 vcc, 160, v0
    v_add_u32 v3, 153792, v3
    s_and_b32 s33, s39, 1
    s_mul_i32 s33, s33, 80
    s_sub_u32 s33, 240, s33
    s_waitcnt lgkmcnt(2)
    v_mfma_f32_32x32x16_bf16 v[160:175], v[200:203], v[112:115], v[160:175]
    ds_read_b64_tr_b16 v[192:193], v214 offset:24576
    ds_read_b64_tr_b16 v[194:195], v214 offset:25600
    v_cndmask_b32 v4, v4, v2, vcc
    v_cndmask_b32 v241, v3, v241, vcc
    v_cmp_gt_u32 vcc, s33, v0
    s_nop 1
    v_cndmask_b32 v243, v5, v4, vcc
    s_lshl_b32 s31, s40, 8
    s_add_u32 s31, s31, 16883712
    s_lshl_b32 s32, s39, 3
    s_waitcnt lgkmcnt(2)
    v_mfma_f32_32x32x16_bf16 v[160:175], v[228:231], v[116:119], v[160:175]
    ds_read_b64_tr_b16 v[200:201], v214 offset:28672
    ds_read_b64_tr_b16 v[202:203], v214 offset:29696
    s_add_u32 s32, s32, s31
    s_cmp_eq_u32 s24, 0
    s_cselect_b32 s100, s32, 0x80000000
    s_lshr_b32 s32, s39, 1
    s_lshl_b32 s32, s32, 7
    s_add_u32 s32, s32, 16818176
    s_lshr_b32 s33, s39, 2
    s_lshl_b32 s33, s33, 8
    s_waitcnt lgkmcnt(2)
    v_mfma_f32_32x32x16_bf16 v[160:175], v[192:195], v[120:123], v[160:175]
    s_waitcnt vmcnt(2)
    s_barrier
    ds_read_b64_tr_b16 v[228:229], v212 offset:32768
    ds_read_b64_tr_b16 v[230:231], v212 offset:33792
    s_add_u32 s33, s33, 16850944
    v_and_b32 v0, 15, v236
    v_and_b32 v1, 7, v236
    v_lshl_add_u32 v3, v0, 4, s33
    v_lshl_add_u32 v4, v1, 4, s32
    v_cmp_gt_u32 vcc, 16, v236
    v_lshl_add_u32 v0, v0, 4, s31
    s_nop 0
    s_waitcnt lgkmcnt(2)
    v_mfma_f32_32x32x16_bf16 v[160:175], v[200:203], v[124:127], v[160:175]
    ds_read_b64_tr_b16 v[192:193], v212 offset:36864
    ds_read_b64_tr_b16 v[194:195], v212 offset:37888
    v_cndmask_b32 v3, v4, v3, vcc
    v_cmp_gt_u32 vcc, 32, v236
    s_nop 1
    v_cndmask_b32 v251, v0, v3, vcc
    s_mul_i32 s31, s25, 81920
    s_lshl_b32 s32, s26, 1
    s_lshr_b32 s33, s28, 1
    s_add_u32 s32, s32, s33
    s_waitcnt lgkmcnt(2)
    v_mfma_f32_32x32x16_bf16 v[160:175], v[228:231], v[128:131], v[160:175]
    ds_read_b64_tr_b16 v[200:201], v212 offset:40960
    ds_read_b64_tr_b16 v[202:203], v212 offset:41984
    s_cmp_eq_u32 s24, 4
    s_cbranch_scc0 L_p1s
    v_mov_b32 v220, 0
    v_mov_b32 v222, 0
    buffer_load_dwordx4 v[220:223], v254, s[16:19], 0 offen sc1
L_p1s:
    s_mul_i32 s32, s32, 5120
    s_add_u32 s31, s31, s32
    s_and_b32 s33, s28, 1
    s_lshl_b32 s32, s33, 11
    s_add_u32 s32, s32, s31
    s_lshl_b32 s33, s33, 9
    s_add_u32 s33, s33, s31
    s_add_u32 s33, s33, 4096
    s_waitcnt lgkmcnt(2)
    v_mfma_f32_32x32x16_bf16 v[160:175], v[192:195], v[132:135], v[160:175]
    ds_read_b64_tr_b16 v[228:229], v212 offset:45056
    ds_read_b64_tr_b16 v[230:231], v212 offset:46080
    s_lshl_b32 s31, s26, 3
    s_lshl_b32 s29, s28, 1
    s_add_u32 s29, s31, s29
    s_lshl_b32 s30, s29, 7
    s_lshl_b32 s31, s27, 6
    s_add_u32 s30, s30, s31
    s_add_u32 s30, s30, 16777216
    s_mul_i32 s36, s25, 163840
    s_waitcnt lgkmcnt(2)
    v_mfma_f32_32x32x16_bf16 v[160:175], v[200:203], v[136:139], v[160:175]
    ds_read_b64_tr_b16 v[192:193], v214 offset:32768
    ds_read_b64_tr_b16 v[194:195], v214 offset:33792
    s_add_u32 s36, s36, 2621440
    s_add_u32 s34, s36, s65
    s_mov_b32 s38, 0x000fffff
    s_mov_b32 s39, 0x000fffff
    s_mov_b64 s[20:21], s[50:51]
    s_mov_b32 s22, 2621440
    v_lshrrev_b32 v2, 5, v236
    v_add_u32 v252, s0, v255
    s_waitcnt lgkmcnt(2)
    v_mfma_f32_32x32x16_bf16 v[160:175], v[228:231], v[140:143], v[160:175]
    ds_read_b64_tr_b16 v[200:201], v214 offset:36864
    ds_read_b64_tr_b16 v[202:203], v214 offset:37888
    v_and_b32 v0, 31, v236
    v_mul_u32_u24 v3, 320, v2
    v_lshl_add_u32 v3, v0, 4, v3
    v_add_u32 v3, 5120, v3
    v_add_u32 v253, s0, v3
    v_and_b32 v0, 15, v236
    s_mul_i32 s31, s13, 5120
    s_add_u32 s31, s31, s0
    s_waitcnt lgkmcnt(2)
    v_mfma_f32_32x32x16_bf16 v[160:175], v[192:195], v[144:147], v[160:175]
    ds_read_b64_tr_b16 v[228:229], v214 offset:40960
    ds_read_b64_tr_b16 v[230:231], v214 offset:41984
    s_cmp_eq_u32 s24, 4
    s_cbranch_scc0 L_pbs
    buffer_load_dwordx4 v[16:19], v254, s[16:19], 0 offen sc1
L_pbs:
    v_add_u32 v250, s31, v255
    v_lshrrev_b32 v3, 4, v236
    v_lshlrev_b32 v0, 4, v0
    v_lshl_add_u32 v249, v3, 9, v0
    s_lshl_b32 s31, s3, 8
    v_add_u32 v249, s31, v249
    v_add_u32 v248, 98304, v249
    s_waitcnt lgkmcnt(2)
    v_mfma_f32_32x32x16_bf16 v[160:175], v[200:203], v[148:151], v[160:175]
    ds_read_b64_tr_b16 v[192:193], v214 offset:45056
    ds_read_b64_tr_b16 v[194:195], v214 offset:46080
    s_waitcnt lgkmcnt(2)
    v_mfma_f32_32x32x16_bf16 v[160:175], v[228:231], v[152:155], v[160:175]
    v_mov_b32 v14, 139264
    s_cmp_eq_u32 s24, 4
    s_cbranch_scc0 L_c1o
    s_waitcnt vmcnt(2)
    v_cmp_ne_u64 vcc, s[44:45], v[220:221]
    v_cmp_ne_u64 s[46:47], s[44:45], v[222:223]
    s_nop 0
    s_or_b64 vcc, vcc, s[46:47]
    s_or_b32 s14, vcc_lo, vcc_hi
    v_mov_b32 v13, s14
    s_mov_b64 exec, 1
    ds_write_b32 v14, v13
    s_mov_b64 exec, -1
    buffer_load_dwordx4 v[220:223], v254, s[16:19], 0 offen sc1
    s_waitcnt lgkmcnt(0)
    s_branch L_c1s
L_c1o:
    s_waitcnt vmcnt(0)
L_c1s:
    s_barrier
    ds_read_b32 v13, v14
    ds_read_b64_tr_b16 v[216:217], v240 offset:0
    ds_read_b64_tr_b16 v[218:219], v240 offset:1280
    ds_read_b64_tr_b16 v[244:245], v241 offset:0
    ds_read_b64_tr_b16 v[246:247], v241 offset:1280
    s_waitcnt lgkmcnt(5)
    v_mfma_f32_32x32x16_bf16 v[160:175], v[192:195], v[156:159], v[160:175]
    s_waitcnt lgkmcnt(4)
    v_readfirstlane_b32 s14, v13
    s_cmp_eq_u32 s14, 0
    s_cbranch_scc0 L_early1
    s_mov_b32 m0, s35
    s_add_u32 s37, s35, s36
    buffer_load_dwordx4 v255, s[16:19], s37 offen offset:0 sc1 lds
    buffer_load_dwordx4 v255, s[16:19], s37 offen offset:1024 sc1 lds
    buffer_load_dwordx4 v255, s[16:19], s37 offen offset:2048 sc1 lds
    buffer_load_dwordx4 v255, s[16:19], s37 offen offset:3072 sc1 lds
    s_add_u32 m0, s35, 4096
    s_add_u32 s37, s37, 4096
    buffer_load_dwordx4 v255, s[16:19], s37 offen offset:0 sc1 lds
    buffer_load_dwordx4 v[96:99], v255, s[16:19], s32 offen sc1
    buffer_load_dwordx4 v[100:103], v255, s[16:19], s32 offen offset:1024 sc1
    buffer_load_dwordx4 v[108:111], v12, s[16:19], s33 offen sc1
L_early1:
    s_cmp_eq_u32 s14, 0
    s_cbranch_scc0 L_late1
L_late1_ret:
    v_mov_b64 v[64:65], 0
    v_mov_b64 v[66:67], 0
    v_mov_b64 v[68:69], 0
    v_mov_b64 v[70:71], 0
    v_mov_b64 v[72:73], 0
    v_mov_b64 v[74:75], 0
    v_mov_b64 v[76:77], 0
    v_mov_b64 v[78:79], 0
    v_mov_b64 v[80:81], 0
    v_mov_b64 v[82:83], 0
    v_mov_b64 v[84:85], 0
    v_mov_b64 v[86:87], 0
    v_mov_b64 v[88:89], 0
    v_mov_b64 v[90:91], 0
    v_mov_b64 v[92:93], 0
    v_mov_b64 v[94:95], 0
    v_bfe_u32 v0, v255, 4, 5
    v_mov_b32 v1, 0x3f803f80
    v_cmp_eq_u32 s[40:41], 20, v0
    v_mov_b32 v122, 0xdddddddd
    v_lshrrev_b32 v2, 2, v12
    v_cndmask_b32 v112, 0, v1, s[40:41]
    v_cndmask_b32 v113, 0, v1, s[40:41]
    v_cndmask_b32 v114, 0, v1, s[40:41]
    v_cndmask_b32 v115, 0, v1, s[40:41]
    v_cndmask_b32 v116, 0, v1, s[40:41]
    v_cndmask_b32 v117, 0, v1, s[40:41]
    v_cndmask_b32 v118, 0, v1, s[40:41]
    v_cndmask_b32 v119, 0, v1, s[40:41]
    v_and_b32 v3, 64, v2
    v_add_u32 v123, v2, v3
    v_bfe_u32 v2, v255, 8, 1
    v_mul_u32_u24 v2, 32512, v2
    v_add_u32 v126, v2, v255
    v_mov_b64 v[236:237], -1
    v_mov_b64 v[238:239], -1
    v_cvt_pk_bf16_f32 v192, v160, v161
    v_cvt_pk_bf16_f32 v193, v162, v163
    v_cvt_pk_bf16_f32 v194, v164, v165
    v_cvt_pk_bf16_f32 v195, v166, v167
    v_pk_max_i16 v192, v192, 0
    v_pk_max_i16 v193, v193, 0
    v_pk_max_i16 v194, v194, 0
    v_pk_max_i16 v195, v195, 0
    v_cvt_pk_bf16_f32 v196, v168, v169
    v_cvt_pk_bf16_f32 v197, v170, v171
    v_cvt_pk_bf16_f32 v198, v172, v173
    v_cvt_pk_bf16_f32 v199, v174, v175
    v_pk_max_i16 v196, v196, 0
    v_pk_max_i16 v197, v197, 0
    v_pk_max_i16 v198, v198, 0
    v_pk_max_i16 v199, v199, 0
    v_mov_b32 v208, 0x80000000
    s_lshr_b32 s31, s24, 1
    s_xor_b32 s13, s31, 0
    s_lshl_b32 s13, s13, 10
    v_add_u32 v224, s13, v250
    v_add_u32 v229, 71680, v224
    s_xor_b32 s13, s31, 1
    s_lshl_b32 s13, s13, 10
    v_add_u32 v225, s13, v250
    v_add_u32 v230, 71680, v225
    s_xor_b32 s13, s31, 2
    s_lshl_b32 s13, s13, 10
    v_add_u32 v226, s13, v250
    v_add_u32 v231, 71680, v226
    s_xor_b32 s13, s31, 3
    s_lshl_b32 s13, s13, 10
    v_add_u32 v227, s13, v250
    v_add_u32 v232, 71680, v227
    v_add_u32 v228, 4096, v250
    v_add_u32 v233, 71680, v228
    s_lshl_b32 s31, s24, 6
    v_lshrrev_b32 v2, 4, v255
    v_add_u32 v2, s31, v2
    v_lshlrev_b32 v3, 7, v2
    s_mul_i32 s31, s26, 12800
    s_add_u32 s31, s31, s1
    v_cmp_gt_u32 vcc, 100, v2
    v_add_u32 v3, s31, v3
    v_mov_b32 v2, 0x80000000
    s_nop 0
    v_cndmask_b32 v234, v2, v3, vcc
    s_branch L_p2_done
L_p1_v:
    s_sub_u32 s42, s28, 40
    s_lshl_b32 s31, s34, 1
    s_add_u32 s42, s42, s31
    s_lshl_b32 s42, s42, 5
    s_mul_i32 s40, s25, 10240
    s_lshr_b32 s31, s35, 1
    s_mul_i32 s31, s31, 2560
    s_add_u32 s40, s40, s31
    s_and_b32 s31, s35, 1
    s_mul_i32 s31, s31, 640
    s_add_u32 s40, s40, s31
    s_add_u32 s40, s40, 2626560
    s_mov_b32 s39, 163840
    v_and_b32 v228, 31, v236
    v_mul_u32_u24 v230, 320, v230
    v_add_u32 v230, s40, v230
    v_add_u32 v229, s42, v228
    v_mul_u32_u24 v231, 3277, v229
    v_lshrrev_b32 v231, 16, v231
    v_mul_u32_u24 v232, 20, v231
    v_sub_u32 v229, v229, v232
    v_mul_lo_u32 v231, v231, s39
    v_lshl_add_u32 v229, v229, 4, v230
    v_add_u32 v220, v229, v231
    v_add_u32 v221, 1280, v220
    v_add_u32 v229, s42, v228
    v_add_u32 v229, 32, v229
    v_mul_u32_u24 v231, 3277, v229
    v_lshrrev_b32 v231, 16, v231
    v_mul_u32_u24 v232, 20, v231
    v_sub_u32 v229, v229, v232
    v_mul_lo_u32 v231, v231, s39
    v_lshl_add_u32 v229, v229, 4, v230
    v_add_u32 v222, v229, v231
    v_add_u32 v223, 1280, v222
    s_cmp_eq_u32 s38, 1
    s_cbranch_scc1 L_p1_vg
    s_lshl_b32 s31, s27, 7
    s_add_u32 m0, s30, 32768
    s_mul_i32 s32, s27, 245760
    buffer_load_dwordx4 v216, s[4:7], s31 offen lds
    s_add_u32 m0, s30, 33792
    s_add_u32 s33, s32, 15360
    buffer_load_dwordx4 v217, s[4:7], s31 offen lds
    s_add_u32 m0, s30, 98304
    s_add_u32 s27, s27, 1
    buffer_load_dwordx4 v218, s[8:11], s32 offen lds
    s_add_u32 m0, s30, 99328
    s_cmp_eq_u32 s27, 10
    s_cselect_b32 s27, 0, s27
    buffer_load_dwordx4 v218, s[8:11], s33 offen lds
    s_waitcnt vmcnt(8)
    s_barrier
    ds_read_b128 v[0:3], v208 offset:0
    ds_read_b64_tr_b16 v[192:193], v212 offset:0
    ds_read_b64_tr_b16 v[194:195], v212 offset:1024
    ds_read_b64_tr_b16 v[196:197], v213 offset:0
    ds_read_b64_tr_b16 v[198:199], v213 offset:1024
    ds_read_b128 v[4:7], v209 offset:0
    ds_read_b64_tr_b16 v[200:201], v212 offset:4096
    ds_read_b64_tr_b16 v[202:203], v212 offset:5120
    ds_read_b64_tr_b16 v[204:205], v213 offset:4096
    ds_read_b64_tr_b16 v[206:207], v213 offset:5120
    s_lshl_b32 s31, s27, 7
    s_add_u32 m0, s30, 49152
    s_mul_i32 s32, s27, 245760
    buffer_load_dwordx4 v216, s[4:7], s31 offen lds
L_site37:
    s_add_u32 m0, s30, 50176
    s_add_u32 s33, s32, 15360
    buffer_load_dwordx4 v217, s[4:7], s31 offen lds
L_site38:
    s_waitcnt lgkmcnt(7)
    v_mfma_f32_32x32x16_bf16 v[160:175], v[0:3], v[192:195], 0
    ds_read_b128 v[8:11], v210 offset:0
    ds_read_b64_tr_b16 v[228:229], v212 offset:8192
    ds_read_b64_tr_b16 v[230:231], v212 offset:9216
    s_add_u32 m0, s30, 114688
    s_add_u32 s27, s27, 1
    buffer_load_dwordx4 v218, s[8:11], s32 offen lds
L_site39:
    s_waitcnt lgkmcnt(8)
    v_mfma_f32_32x32x16_bf16 v[176:191], v[0:3], v[196:199], 0
    ds_read_b64_tr_b16 v[232:233], v213 offset:8192
    ds_read_b64_tr_b16 v[234:235], v213 offset:9216
    s_waitcnt lgkmcnt(7)
    v_mfma_f32_32x32x16_bf16 v[160:175], v[4:7], v[200:203], v[160:175]
    ds_read_b128 v[12:15], v211 offset:0
    ds_read_b64_tr_b16 v[192:193], v212 offset:12288
    ds_read_b64_tr_b16 v[194:195], v212 offset:13312
    s_add_u32 m0, s30, 115712
    s_cmp_eq_u32 s27, 10
    s_cselect_b32 s27, 0, s27
    buffer_load_dwordx4 v218, s[8:11], s33 offen lds
L_site40:
    s_waitcnt lgkmcnt(8)
    v_mfma_f32_32x32x16_bf16 v[176:191], v[4:7], v[204:207], v[176:191]
    ds_read_b64_tr_b16 v[196:197], v213 offset:12288
    ds_read_b64_tr_b16 v[198:199], v213 offset:13312
    s_waitcnt lgkmcnt(7)
    v_mfma_f32_32x32x16_bf16 v[160:175], v[8:11], v[228:231], v[160:175]
    s_waitcnt vmcnt(8) lgkmcnt(0)
    s_barrier
    ds_read_b128 v[16:19], v208 offset:16384
    ds_read_b64_tr_b16 v[200:201], v212 offset:16384
    ds_read_b64_tr_b16 v[202:203], v212 offset:17408
    s_lshl_b32 s31, s27, 7
    s_add_u32 m0, s30, 0
    s_mul_i32 s32, s27, 245760
    buffer_load_dwordx4 v216, s[4:7], s31 offen lds
L_site41:
    s_waitcnt lgkmcnt(8)
    v_mfma_f32_32x32x16_bf16 v[176:191], v[8:11], v[232:235], v[176:191]
    ds_read_b64_tr_b16 v[204:205], v213 offset:16384
    ds_read_b64_tr_b16 v[206:207], v213 offset:17408
    s_waitcnt lgkmcnt(7)
    v_mfma_f32_32x32x16_bf16 v[160:175], v[12:15], v[192:195], v[160:175]
    ds_read_b128 v[20:23], v209 offset:16384
    ds_read_b64_tr_b16 v[228:229], v212 offset:20480
    ds_read_b64_tr_b16 v[230:231], v212 offset:21504
    s_add_u32 m0, s30, 1024
    s_add_u32 s33, s32, 15360
    buffer_load_dwordx4 v217, s[4:7], s31 offen lds
L_site42:
    s_waitcnt lgkmcnt(8)
    v_mfma_f32_32x32x16_bf16 v[176:191], v[12:15], v[196:199], v[176:191]
    ds_read_b64_tr_b16 v[232:233], v213 offset:20480
    ds_read_b64_tr_b16 v[234:235], v213 offset:21504
    s_waitcnt lgkmcnt(7)
    v_mfma_f32_32x32x16_bf16 v[160:175], v[16:19], v[200:203], v[160:175]
    ds_read_b128 v[24:27], v210 offset:16384
    ds_read_b64_tr_b16 v[192:193], v212 offset:24576
    ds_read_b64_tr_b16 v[194:195], v212 offset:25600
    s_add_u32 m0, s30, 65536
    s_add_u32 s27, s27, 1
    buffer_load_dwordx4 v218, s[8:11], s32 offen lds
L_site43:
    s_waitcnt lgkmcnt(8)
    v_mfma_f32_32x32x16_bf16 v[176:191], v[16:19], v[204:207], v[176:191]
    ds_read_b64_tr_b16 v[196:197], v213 offset:24576
    ds_read_b64_tr_b16 v[198:199], v213 offset:25600
    s_waitcnt lgkmcnt(7)
    v_mfma_f32_32x32x16_bf16 v[160:175], v[20:23], v[228:231], v[160:175]
    ds_read_b128 v[28:31], v211 offset:16384
    ds_read_b64_tr_b16 v[200:201], v212 offset:28672
    ds_read_b64_tr_b16 v[202:203], v212 offset:29696
    s_add_u32 m0, s30, 66560
    s_cmp_eq_u32 s27, 10
    s_cselect_b32 s27, 0, s27
    buffer_load_dwordx4 v218, s[8:11], s33 offen lds
L_site44:
    s_waitcnt lgkmcnt(8)
    v_mfma_f32_32x32x16_bf16 v[176:191], v[20:23], v[232:235], v[176:191]
    ds_read_b64_tr_b16 v[204:205], v213 offset:28672
    ds_read_b64_tr_b16 v[206:207], v213 offset:29696
    s_waitcnt lgkmcnt(7)
    v_mfma_f32_32x32x16_bf16 v[160:175], v[24:27], v[192:195], v[160:175]
    s_waitcnt vmcnt(8) lgkmcnt(0)
    s_barrier
    ds_read_b128 v[32:35], v208 offset:32768
    ds_read_b64_tr_b16 v[228:229], v212 offset:32768
    ds_read_b64_tr_b16 v[230:231], v212 offset:33792
    s_lshl_b32 s31, s27, 7
    s_add_u32 m0, s30, 16384
    s_mul_i32 s32, s27, 245760
    buffer_load_dwordx4 v216, s[4:7], s31 offen lds
L_site45:
    s_waitcnt lgkmcnt(8)
    v_mfma_f32_32x32x16_bf16 v[176:191], v[24:27], v[196:199], v[176:191]
    ds_read_b64_tr_b16 v[232:233], v213 offset:32768
    ds_read_b64_tr_b16 v[234:235], v213 offset:33792
    s_waitcnt lgkmcnt(7)
    v_mfma_f32_32x32x16_bf16 v[160:175], v[28:31], v[200:203], v[160:175]
    ds_read_b128 v[36:39], v209 offset:32768
    ds_read_b64_tr_b16 v[192:193], v212 offset:36864
    ds_read_b64_tr_b16 v[194:195], v212 offset:37888
    s_add_u32 m0, s30, 17408
    s_add_u32 s33, s32, 15360
    buffer_load_dwordx4 v217, s[4:7], s31 offen lds
L_site46:
    s_waitcnt lgkmcnt(8)
    v_mfma_f32_32x32x16_bf16 v[176:191], v[28:31], v[204:207], v[176:191]
    ds_read_b64_tr_b16 v[196:197], v213 offset:36864
    ds_read_b64_tr_b16 v[198:199], v213 offset:37888
    s_waitcnt lgkmcnt(7)
    v_mfma_f32_32x32x16_bf16 v[160:175], v[32:35], v[228:231], v[160:175]
    ds_read_b128 v[40:43], v210 offset:32768
    ds_read_b64_tr_b16 v[200:201], v212 offset:40960
    ds_read_b64_tr_b16 v[202:203], v212 offset:41984
    s_add_u32 m0, s30, 81920
    s_add_u32 s27, s27, 1
    buffer_load_dwordx4 v218, s[8:11], s32 offen lds
L_site47:
    s_waitcnt lgkmcnt(8)
    v_mfma_f32_32x32x16_bf16 v[176:191], v[32:35], v[232:235], v[176:191]
    ds_read_b64_tr_b16 v[204:205], v213 offset:40960
    ds_read_b64_tr_b16 v[206:207], v213 offset:41984
    s_waitcnt lgkmcnt(7)
    v_mfma_f32_32x32x16_bf16 v[160:175], v[36:39], v[192:195], v[160:175]
    ds_read_b128 v[44:47], v211 offset:32768
    ds_read_b64_tr_b16 v[228:229], v212 offset:45056
    ds_read_b64_tr_b16 v[230:231], v212 offset:46080
    s_add_u32 m0, s30, 82944
    s_cmp_eq_u32 s27, 10
    s_cselect_b32 s27, 0, s27
    buffer_load_dwordx4 v218, s[8:11], s33 offen lds
L_site48:
    s_waitcnt lgkmcnt(8)
    v_mfma_f32_32x32x16_bf16 v[176:191], v[36:39], v[196:199], v[176:191]
    ds_read_b64_tr_b16 v[232:233], v213 offset:45056
    ds_read_b64_tr_b16 v[234:235], v213 offset:46080
    s_waitcnt lgkmcnt(7)
    v_mfma_f32_32x32x16_bf16 v[160:175], v[40:43], v[200:203], v[160:175]
    s_waitcnt vmcnt(8) lgkmcnt(0)
    s_barrier
    ds_read_b128 v[48:51], v208 offset:49152
    ds_read_b64_tr_b16 v[192:193], v212 offset:49152
    ds_read_b64_tr_b16 v[194:195], v212 offset:50176
    s_lshl_b32 s31, s27, 7
    s_add_u32 m0, s30, 32768
    s_mul_i32 s32, s27, 245760
    buffer_load_dwordx4 v216, s[4:7], s31 offen lds
L_site49:
    s_waitcnt lgkmcnt(8)
    v_mfma_f32_32x32x16_bf16 v[176:191], v[40:43], v[204:207], v[176:191]
    ds_read_b64_tr_b16 v[196:197], v213 offset:49152
    ds_read_b64_tr_b16 v[198:199], v213 offset:50176
    s_waitcnt lgkmcnt(7)
    v_mfma_f32_32x32x16_bf16 v[160:175], v[44:47], v[228:231], v[160:175]
    ds_read_b128 v[52:55], v209 offset:49152
    ds_read_b64_tr_b16 v[200:201], v212 offset:53248
    ds_read_b64_tr_b16 v[202:203], v212 offset:54272
    s_add_u32 m0, s30, 33792
    s_add_u32 s33, s32, 15360
    buffer_load_dwordx4 v217, s[4:7], s31 offen lds
L_site50:
    s_waitcnt lgkmcnt(8)
    v_mfma_f32_32x32x16_bf16 v[176:191], v[44:47], v[232:235], v[176:191]
    ds_read_b64_tr_b16 v[204:205], v213 offset:53248
    ds_read_b64_tr_b16 v[206:207], v213 offset:54272
    s_waitcnt lgkmcnt(7)
    v_mfma_f32_32x32x16_bf16 v[160:175], v[48:51], v[192:195], v[160:175]
    ds_read_b128 v[56:59], v210 offset:49152
    ds_read_b64_tr_b16 v[228:229], v212 offset:57344
    ds_read_b64_tr_b16 v[230:231], v212 offset:58368
    s_add_u32 m0, s30, 98304
    s_add_u32 s27, s27, 1
    buffer_load_dwordx4 v218, s[8:11], s32 offen lds
L_site51:
    s_waitcnt lgkmcnt(8)
    v_mfma_f32_32x32x16_bf16 v[176:191], v[48:51], v[196:199], v[176:191]
    ds_read_b64_tr_b16 v[232:233], v213 offset:57344
    ds_read_b64_tr_b16 v[234:235], v213 offset:58368
    s_waitcnt lgkmcnt(7)
    v_mfma_f32_32x32x16_bf16 v[160:175], v[52:55], v[200:203], v[160:175]
    ds_read_b128 v[60:63], v211 offset:49152
    ds_read_b64_tr_b16 v[192:193], v212 offset:61440
    ds_read_b64_tr_b16 v[194:195], v212 offset:62464
    s_add_u32 m0, s30, 99328
    s_cmp_eq_u32 s27, 10
    s_cselect_b32 s27, 0, s27
    buffer_load_dwordx4 v218, s[8:11], s33 offen lds
L_site52:
    s_waitcnt lgkmcnt(8)
    v_mfma_f32_32x32x16_bf16 v[176:191], v[52:55], v[204:207], v[176:191]
    ds_read_b64_tr_b16 v[196:197], v213 offset:61440
    ds_read_b64_tr_b16 v[198:199], v213 offset:62464
    s_waitcnt lgkmcnt(7)
    v_mfma_f32_32x32x16_bf16 v[160:175], v[56:59], v[228:231], v[160:175]
    s_waitcnt vmcnt(8) lgkmcnt(0)
    s_barrier
    ds_read_b128 v[64:67], v208 offset:0
    ds_read_b64_tr_b16 v[200:201], v212 offset:0
    ds_read_b64_tr_b16 v[202:203], v212 offset:1024
    s_lshl_b32 s31, s27, 7
    s_add_u32 m0, s30, 49152
    s_mul_i32 s32, s27, 245760
    buffer_load_dwordx4 v216, s[4:7], s31 offen lds
L_site53:
    s_waitcnt lgkmcnt(8)
    v_mfma_f32_32x32x16_bf16 v[176:191], v[56:59], v[232:235], v[176:191]
    ds_read_b64_tr_b16 v[204:205], v213 offset:0
    ds_read_b64_tr_b16 v[206:207], v213 offset:1024
    s_waitcnt lgkmcnt(7)
    v_mfma_f32_32x32x16_bf16 v[160:175], v[60:63], v[192:195], v[160:175]
    ds_read_b128 v[68:71], v209 offset:0
    ds_read_b64_tr_b16 v[228:229], v212 offset:4096
    ds_read_b64_tr_b16 v[230:231], v212 offset:5120
    s_add_u32 m0, s30, 50176
    s_add_u32 s33, s32, 15360
    buffer_load_dwordx4 v217, s[4:7], s31 offen lds
L_site54:
    s_waitcnt lgkmcnt(8)
    v_mfma_f32_32x32x16_bf16 v[176:191], v[60:63], v[196:199], v[176:191]
    ds_read_b64_tr_b16 v[232:233], v213 offset:4096
    ds_read_b64_tr_b16 v[234:235], v213 offset:5120
    s_waitcnt lgkmcnt(7)
    v_mfma_f32_32x32x16_bf16 v[160:175], v[64:67], v[200:203], v[160:175]
    ds_read_b128 v[72:75], v210 offset:0
    ds_read_b64_tr_b16 v[192:193], v212 offset:8192
    ds_read_b64_tr_b16 v[194:195], v212 offset:9216
    s_add_u32 m0, s30, 114688
    s_add_u32 s27, s27, 1
    buffer_load_dwordx4 v218, s[8:11], s32 offen lds
L_site55:
    s_waitcnt lgkmcnt(8)
    v_mfma_f32_32x32x16_bf16 v[176:191], v[64:67], v[204:207], v[176:191]
    ds_read_b64_tr_b16 v[196:197], v213 offset:8192
    ds_read_b64_tr_b16 v[198:199], v213 offset:9216
    s_waitcnt lgkmcnt(7)
    v_mfma_f32_32x32x16_bf16 v[160:175], v[68:71], v[228:231], v[160:175]
    ds_read_b128 v[76:79], v211 offset:0
    ds_read_b64_tr_b16 v[200:201], v212 offset:12288
    ds_read_b64_tr_b16 v[202:203], v212 offset:13312
    s_add_u32 m0, s30, 115712
    s_cmp_eq_u32 s27, 10
    s_cselect_b32 s27, 0, s27
    buffer_load_dwordx4 v218, s[8:11], s33 offen lds
    global_load_dword v251, v251, s[98:99]
L_site56:
    s_waitcnt lgkmcnt(8)
    v_mfma_f32_32x32x16_bf16 v[176:191], v[68:71], v[232:235], v[176:191]
    ds_read_b64_tr_b16 v[204:205], v213 offset:12288
    ds_read_b64_tr_b16 v[206:207], v213 offset:13312
    s_waitcnt lgkmcnt(7)
    v_mfma_f32_32x32x16_bf16 v[160:175], v[72:75], v[192:195], v[160:175]
    s_waitcnt vmcnt(9) lgkmcnt(0)
    s_barrier
    ds_read_b128 v[80:83], v208 offset:16384
    ds_read_b64_tr_b16 v[228:229], v212 offset:16384
    ds_read_b64_tr_b16 v[230:231], v212 offset:17408
    s_lshl_b32 s31, s27, 7
    s_add_u32 m0, s30, 0
    s_mul_i32 s32, s27, 245760
    buffer_load_dwordx4 v216, s[4:7], s31 offen lds
L_site57:
    s_waitcnt lgkmcnt(8)
    v_mfma_f32_32x32x16_bf16 v[176:191], v[72:75], v[196:199], v[176:191]
    ds_read_b64_tr_b16 v[232:233], v213 offset:16384
    ds_read_b64_tr_b16 v[234:235], v213 offset:17408
    s_waitcnt lgkmcnt(7)
    v_mfma_f32_32x32x16_bf16 v[160:175], v[76:79], v[200:203], v[160:175]
    ds_read_b128 v[84:87], v209 offset:16384
    ds_read_b64_tr_b16 v[192:193], v212 offset:20480
    ds_read_b64_tr_b16 v[194:195], v212 offset:21504
    s_add_u32 m0, s30, 1024
    s_add_u32 s33, s32, 15360
    buffer_load_dwordx4 v217, s[4:7], s31 offen lds
L_site58:
    s_waitcnt lgkmcnt(8)
    v_mfma_f32_32x32x16_bf16 v[176:191], v[76:79], v[204:207], v[176:191]
    ds_read_b64_tr_b16 v[196:197], v213 offset:20480
    ds_read_b64_tr_b16 v[198:199], v213 offset:21504
    s_waitcnt lgkmcnt(7)
    v_mfma_f32_32x32x16_bf16 v[160:175], v[80:83], v[228:231], v[160:175]
    ds_read_b128 v[88:91], v210 offset:16384
    ds_read_b64_tr_b16 v[200:201], v212 offset:24576
    ds_read_b64_tr_b16 v[202:203], v212 offset:25600
    s_add_u32 m0, s30, 65536
    s_add_u32 s27, s27, 1
    buffer_load_dwordx4 v218, s[8:11], s32 offen lds
L_site59:
    s_waitcnt lgkmcnt(8)
    v_mfma_f32_32x32x16_bf16 v[176:191], v[80:83], v[232:235], v[176:191]
    ds_read_b64_tr_b16 v[204:205], v213 offset:24576
    ds_read_b64_tr_b16 v[206:207], v213 offset:25600
    s_waitcnt lgkmcnt(7)
    v_mfma_f32_32x32x16_bf16 v[160:175], v[84:87], v[192:195], v[160:175]
    ds_read_b128 v[92:95], v211 offset:16384
    ds_read_b64_tr_b16 v[228:229], v212 offset:28672
    ds_read_b64_tr_b16 v[230:231], v212 offset:29696
    s_add_u32 m0, s30, 66560
    s_cmp_eq_u32 s27, 10
    s_cselect_b32 s27, 0, s27
    buffer_load_dwordx4 v218, s[8:11], s33 offen lds
L_site60:
    s_waitcnt lgkmcnt(8)
    v_mfma_f32_32x32x16_bf16 v[176:191], v[84:87], v[196:199], v[176:191]
    ds_read_b64_tr_b16 v[232:233], v213 offset:28672
    ds_read_b64_tr_b16 v[234:235], v213 offset:29696
    s_waitcnt lgkmcnt(7)
    v_mfma_f32_32x32x16_bf16 v[160:175], v[88:91], v[200:203], v[160:175]
    s_waitcnt vmcnt(9) lgkmcnt(0)
    s_barrier
    ds_read_b128 v[96:99], v208 offset:32768
    ds_read_b64_tr_b16 v[192:193], v212 offset:32768
    ds_read_b64_tr_b16 v[194:195], v212 offset:33792
    s_lshl_b32 s31, s27, 7
    s_add_u32 m0, s30, 16384
    s_mul_i32 s32, s27, 245760
    buffer_load_dwordx4 v216, s[4:7], s31 offen lds
L_site61:
    s_waitcnt lgkmcnt(8)
    v_mfma_f32_32x32x16_bf16 v[176:191], v[88:91], v[204:207], v[176:191]
    ds_read_b64_tr_b16 v[196:197], v213 offset:32768
    ds_read_b64_tr_b16 v[198:199], v213 offset:33792
    s_waitcnt lgkmcnt(7)
    v_mfma_f32_32x32x16_bf16 v[160:175], v[92:95], v[228:231], v[160:175]
    ds_read_b128 v[100:103], v209 offset:32768
    ds_read_b64_tr_b16 v[200:201], v212 offset:36864
    ds_read_b64_tr_b16 v[202:203], v212 offset:37888
    s_add_u32 m0, s30, 17408
    s_add_u32 s33, s32, 15360
    buffer_load_dwordx4 v217, s[4:7], s31 offen lds
L_site62:
    s_waitcnt lgkmcnt(8)
    v_mfma_f32_32x32x16_bf16 v[176:191], v[92:95], v[232:235], v[176:191]
    ds_read_b64_tr_b16 v[204:205], v213 offset:36864
    ds_read_b64_tr_b16 v[206:207], v213 offset:37888
    s_waitcnt lgkmcnt(7)
    v_mfma_f32_32x32x16_bf16 v[160:175], v[96:99], v[192:195], v[160:175]
    ds_read_b128 v[104:107], v210 offset:32768
    ds_read_b64_tr_b16 v[228:229], v212 offset:40960
    ds_read_b64_tr_b16 v[230:231], v212 offset:41984
    s_add_u32 m0, s30, 81920
    s_add_u32 s27, s27, 1
    buffer_load_dwordx4 v218, s[8:11], s32 offen lds
L_site63:
    s_waitcnt lgkmcnt(8)
    v_mfma_f32_32x32x16_bf16 v[176:191], v[96:99], v[196:199], v[176:191]
    ds_read_b64_tr_b16 v[232:233], v213 offset:40960
    ds_read_b64_tr_b16 v[234:235], v213 offset:41984
    s_waitcnt lgkmcnt(7)
    v_mfma_f32_32x32x16_bf16 v[160:175], v[100:103], v[200:203], v[160:175]
    ds_read_b128 v[108:111], v211 offset:32768
    ds_read_b64_tr_b16 v[192:193], v212 offset:45056
    ds_read_b64_tr_b16 v[194:195], v212 offset:46080
    s_add_u32 m0, s30, 82944
    s_cmp_eq_u32 s27, 10
    s_cselect_b32 s27, 0, s27
    buffer_load_dwordx4 v218, s[8:11], s33 offen lds
    buffer_load_dwordx2 v[238:239], off, s[52:55], 0
    s_mov_b32 exec_lo, 0x7fff
    s_mov_b32 exec_hi, 0x0
    buffer_load_dword v255, v254, s[12:15], 0 offen
    s_mov_b64 exec, -1
L_site64:
    s_waitcnt lgkmcnt(8)
    v_mfma_f32_32x32x16_bf16 v[176:191], v[100:103], v[204:207], v[176:191]
    ds_read_b64_tr_b16 v[196:197], v213 offset:45056
    ds_read_b64_tr_b16 v[198:199], v213 offset:46080
    s_waitcnt lgkmcnt(7)
    v_mfma_f32_32x32x16_bf16 v[160:175], v[104:107], v[228:231], v[160:175]
    s_waitcnt vmcnt(11) lgkmcnt(0)
    s_barrier
    ds_read_b128 v[112:115], v208 offset:49152
    ds_read_b64_tr_b16 v[200:201], v212 offset:49152
    ds_read_b64_tr_b16 v[202:203], v212 offset:50176
    s_waitcnt lgkmcnt(8)
    v_mfma_f32_32x32x16_bf16 v[176:191], v[104:107], v[232:235], v[176:191]
    ds_read_b64_tr_b16 v[204:205], v213 offset:49152
    ds_read_b64_tr_b16 v[206:207], v213 offset:50176
    s_waitcnt lgkmcnt(7)
    v_mfma_f32_32x32x16_bf16 v[160:175], v[108:111], v[192:195], v[160:175]
    ds_read_b128 v[116:119], v209 offset:49152
    ds_read_b64_tr_b16 v[228:229], v212 offset:53248
    ds_read_b64_tr_b16 v[230:231], v212 offset:54272
    s_waitcnt lgkmcnt(8)
    v_mfma_f32_32x32x16_bf16 v[176:191], v[108:111], v[196:199], v[176:191]
    ds_read_b64_tr_b16 v[232:233], v213 offset:53248
    ds_read_b64_tr_b16 v[234:235], v213 offset:54272
    s_waitcnt lgkmcnt(7)
    v_mfma_f32_32x32x16_bf16 v[160:175], v[112:115], v[200:203], v[160:175]
    ds_read_b128 v[120:123], v210 offset:49152
    ds_read_b64_tr_b16 v[192:193], v212 offset:57344
    ds_read_b64_tr_b16 v[194:195], v212 offset:58368
    s_waitcnt lgkmcnt(8)
    v_mfma_f32_32x32x16_bf16 v[176:191], v[112:115], v[204:207], v[176:191]
    ds_read_b64_tr_b16 v[196:197], v213 offset:57344
    ds_read_b64_tr_b16 v[198:199], v213 offset:58368
    s_waitcnt lgkmcnt(7)
    v_mfma_f32_32x32x16_bf16 v[160:175], v[116:119], v[228:231], v[160:175]
    ds_read_b128 v[124:127], v211 offset:49152
    ds_read_b64_tr_b16 v[200:201], v212 offset:61440
    ds_read_b64_tr_b16 v[202:203], v212 offset:62464
    s_waitcnt lgkmcnt(8)
    v_mfma_f32_32x32x16_bf16 v[176:191], v[116:119], v[232:235], v[176:191]
    ds_read_b64_tr_b16 v[204:205], v213 offset:61440
    ds_read_b64_tr_b16 v[206:207], v213 offset:62464
    s_waitcnt lgkmcnt(7)
    v_mfma_f32_32x32x16_bf16 v[160:175], v[120:123], v[192:195], v[160:175]
    s_waitcnt vmcnt(6) lgkmcnt(0)
    s_barrier
    ds_read_b128 v[128:131], v208 offset:0
    ds_read_b64_tr_b16 v[228:229], v212 offset:0
    ds_read_b64_tr_b16 v[230:231], v212 offset:1024
    s_mul_i32 s32, s27, 196608
    s_add_u32 m0, s30, 98304
    s_add_u32 s33, s32, 12288
    buffer_load_dwordx4 v219, s[12:15], s32 offen lds
L_site65:
    s_waitcnt lgkmcnt(8)
    v_mfma_f32_32x32x16_bf16 v[176:191], v[120:123], v[196:199], v[176:191]
    ds_read_b64_tr_b16 v[232:233], v213 offset:0
    ds_read_b64_tr_b16 v[234:235], v213 offset:1024
    s_waitcnt lgkmcnt(7)
    v_mfma_f32_32x32x16_bf16 v[160:175], v[124:127], v[200:203], v[160:175]
    ds_read_b128 v[132:135], v209 offset:0
    ds_read_b64_tr_b16 v[192:193], v212 offset:4096
    ds_read_b64_tr_b16 v[194:195], v212 offset:5120
    s_add_u32 m0, s30, 99328
    s_add_u32 s27, s27, 1
    s_cmp_eq_u32 s27, 10
    s_cselect_b32 s27, 0, s27
    buffer_load_dwordx4 v219, s[12:15], s33 offen lds
L_site66:
    s_waitcnt lgkmcnt(8)
    v_mfma_f32_32x32x16_bf16 v[176:191], v[124:127], v[204:207], v[176:191]
    ds_read_b64_tr_b16 v[196:197], v213 offset:4096
    ds_read_b64_tr_b16 v[198:199], v213 offset:5120
    s_waitcnt lgkmcnt(7)
    v_mfma_f32_32x32x16_bf16 v[160:175], v[128:131], v[228:231], v[160:175]
    ds_read_b128 v[136:139], v210 offset:0
    ds_read_b64_tr_b16 v[200:201], v212 offset:8192
    ds_read_b64_tr_b16 v[202:203], v212 offset:9216
    s_mul_i32 s32, s27, 196608
    s_add_u32 m0, s30, 32768
    s_add_u32 s33, s32, 12288
    buffer_load_dwordx4 v219, s[12:15], s32 offen lds
L_site67:
    s_waitcnt lgkmcnt(8)
    v_mfma_f32_32x32x16_bf16 v[176:191], v[128:131], v[232:235], v[176:191]
    ds_read_b64_tr_b16 v[204:205], v213 offset:8192
    ds_read_b64_tr_b16 v[206:207], v213 offset:9216
    s_waitcnt lgkmcnt(7)
    v_mfma_f32_32x32x16_bf16 v[160:175], v[132:135], v[192:195], v[160:175]
    ds_read_b128 v[140:143], v211 offset:0
    ds_read_b64_tr_b16 v[228:229], v212 offset:12288
    ds_read_b64_tr_b16 v[230:231], v212 offset:13312
    s_add_u32 m0, s30, 33792
    s_add_u32 s27, s27, 1
    s_cmp_eq_u32 s27, 10
    s_cselect_b32 s27, 0, s27
    buffer_load_dwordx4 v219, s[12:15], s33 offen lds
L_site68:
    s_waitcnt lgkmcnt(8)
    v_mfma_f32_32x32x16_bf16 v[176:191], v[132:135], v[196:199], v[176:191]
    ds_read_b64_tr_b16 v[232:233], v213 offset:12288
    ds_read_b64_tr_b16 v[234:235], v213 offset:13312
    s_waitcnt lgkmcnt(7)
    v_mfma_f32_32x32x16_bf16 v[160:175], v[136:139], v[200:203], v[160:175]
    s_waitcnt vmcnt(5) lgkmcnt(0)
    s_barrier
    ds_read_b128 v[144:147], v208 offset:16384
    ds_read_b64_tr_b16 v[192:193], v212 offset:16384
    ds_read_b64_tr_b16 v[194:195], v212 offset:17408
    s_mul_i32 s32, s27, 196608
    s_add_u32 m0, s30, 114688
    s_add_u32 s33, s32, 12288
    buffer_load_dwordx4 v219, s[12:15], s32 offen lds
L_site69:
    s_waitcnt lgkmcnt(8)
    v_mfma_f32_32x32x16_bf16 v[176:191], v[136:139], v[204:207], v[176:191]
    ds_read_b64_tr_b16 v[196:197], v213 offset:16384
    ds_read_b64_tr_b16 v[198:199], v213 offset:17408
    s_waitcnt lgkmcnt(7)
    v_mfma_f32_32x32x16_bf16 v[160:175], v[140:143], v[228:231], v[160:175]
    ds_read_b128 v[148:151], v209 offset:16384
    ds_read_b64_tr_b16 v[200:201], v212 offset:20480
    ds_read_b64_tr_b16 v[202:203], v212 offset:21504
    s_add_u32 m0, s30, 115712
    s_add_u32 s27, s27, 1
    s_cmp_eq_u32 s27, 10
    s_cselect_b32 s27, 0, s27
    buffer_load_dwordx4 v219, s[12:15], s33 offen lds
L_site70:
    s_waitcnt lgkmcnt(8)
    v_mfma_f32_32x32x16_bf16 v[176:191], v[140:143], v[232:235], v[176:191]
    ds_read_b64_tr_b16 v[204:205], v213 offset:20480
    ds_read_b64_tr_b16 v[206:207], v213 offset:21504
    s_waitcnt lgkmcnt(7)
    v_mfma_f32_32x32x16_bf16 v[160:175], v[144:147], v[192:195], v[160:175]
    ds_read_b128 v[152:155], v210 offset:16384
    ds_read_b64_tr_b16 v[228:229], v212 offset:24576
    ds_read_b64_tr_b16 v[230:231], v212 offset:25600
    s_mul_i32 s32, s27, 196608
    s_add_u32 m0, s30, 49152
    s_add_u32 s33, s32, 12288
    buffer_load_dwordx4 v219, s[12:15], s32 offen lds
L_site71:
    s_waitcnt lgkmcnt(8)
    v_mfma_f32_32x32x16_bf16 v[176:191], v[144:147], v[196:199], v[176:191]
    ds_read_b64_tr_b16 v[232:233], v213 offset:24576
    ds_read_b64_tr_b16 v[234:235], v213 offset:25600
    s_waitcnt lgkmcnt(7)
    v_mfma_f32_32x32x16_bf16 v[160:175], v[148:151], v[200:203], v[160:175]
    ds_read_b128 v[156:159], v211 offset:16384
    ds_read_b64_tr_b16 v[192:193], v212 offset:28672
    ds_read_b64_tr_b16 v[194:195], v212 offset:29696
    s_add_u32 m0, s30, 50176
    s_add_u32 s27, s27, 1
    s_cmp_eq_u32 s27, 10
    s_cselect_b32 s27, 0, s27
    buffer_load_dwordx4 v219, s[12:15], s33 offen lds
L_site72:
    s_waitcnt lgkmcnt(8)
    v_mfma_f32_32x32x16_bf16 v[176:191], v[148:151], v[204:207], v[176:191]
    ds_read_b64_tr_b16 v[196:197], v213 offset:28672
    ds_read_b64_tr_b16 v[198:199], v213 offset:29696
    s_waitcnt lgkmcnt(7)
    v_mfma_f32_32x32x16_bf16 v[160:175], v[152:155], v[228:231], v[160:175]
    s_waitcnt vmcnt(4) lgkmcnt(0)
    s_barrier
    s_waitcnt lgkmcnt(5)
    v_mfma_f32_32x32x16_bf16 v[176:191], v[152:155], v[232:235], v[176:191]
    s_waitcnt lgkmcnt(2)
    v_mfma_f32_32x32x16_bf16 v[160:175], v[156:159], v[192:195], v[160:175]
    s_waitcnt lgkmcnt(0)
    v_mfma_f32_32x32x16_bf16 v[176:191], v[156:159], v[196:199], v[176:191]
    s_nop 7
    s_nop 1
    v_cvt_pk_bf16_f32 v224, v160, v161
    v_cvt_pk_bf16_f32 v225, v162, v163
    v_cvt_pk_bf16_f32 v226, v164, v165
    v_cvt_pk_bf16_f32 v227, v166, v167
    s_nop 1
    v_permlane32_swap_b32 v224, v226
    v_permlane32_swap_b32 v225, v227
    buffer_store_dwordx4 v[224:227], v220, s[16:19], 0 offen sc1
    v_cvt_pk_bf16_f32 v240, v168, v169
    v_cvt_pk_bf16_f32 v241, v170, v171
    v_cvt_pk_bf16_f32 v242, v172, v173
    v_cvt_pk_bf16_f32 v243, v174, v175
    s_nop 1
    v_permlane32_swap_b32 v240, v242
    v_permlane32_swap_b32 v241, v243
    buffer_store_dwordx4 v[240:243], v221, s[16:19], 0 offen sc1
    v_cvt_pk_bf16_f32 v244, v176, v177
    v_cvt_pk_bf16_f32 v245, v178, v179
    v_cvt_pk_bf16_f32 v246, v180, v181
    v_cvt_pk_bf16_f32 v247, v182, v183
    s_nop 1
    v_permlane32_swap_b32 v244, v246
    v_permlane32_swap_b32 v245, v247
    buffer_store_dwordx4 v[244:247], v222, s[16:19], 0 offen sc1
    v_cvt_pk_bf16_f32 v248, v184, v185
    v_cvt_pk_bf16_f32 v249, v186, v187
    v_cvt_pk_bf16_f32 v250, v188, v189
    v_cvt_pk_bf16_f32 v251, v190, v191
    s_nop 1
    v_permlane32_swap_b32 v248, v250
    v_permlane32_swap_b32 v249, v251
    buffer_store_dwordx4 v[248:251], v223, s[16:19], 0 offen sc1
    s_branch L_p2
L_p1_vg:
    v_mov_b32 v222, 0x80000000
    v_mov_b32 v223, 0x80000000
    s_lshl_b32 s31, s27, 7
    s_add_u32 m0, s30, 32768
    s_mul_i32 s32, s27, 245760
    buffer_load_dwordx4 v216, s[4:7], s31 offen lds
    s_add_u32 m0, s30, 33792
    s_add_u32 s33, s32, 15360
    buffer_load_dwordx4 v217, s[4:7], s31 offen lds
    s_add_u32 m0, s30, 98304
    s_add_u32 s27, s27, 1
    buffer_load_dwordx4 v218, s[8:11], s32 offen lds
    s_add_u32 m0, s30, 99328
    s_cmp_eq_u32 s27, 10
    s_cselect_b32 s27, 0, s27
    buffer_load_dwordx4 v218, s[8:11], s33 offen lds
    s_waitcnt vmcnt(8)
    s_barrier
    ds_read_b128 v[0:3], v208 offset:0
    ds_read_b64_tr_b16 v[192:193], v212 offset:0
    ds_read_b64_tr_b16 v[194:195], v212 offset:1024
    ds_read_b128 v[196:199], v237 offset:0
    ds_read_b128 v[4:7], v209 offset:0
    ds_read_b64_tr_b16 v[200:201], v212 offset:4096
    ds_read_b64_tr_b16 v[202:203], v212 offset:5120
    ds_read_b128 v[204:207], v237 offset:32
    s_lshl_b32 s31, s27, 7
    s_add_u32 m0, s30, 49152
    s_mul_i32 s32, s27, 245760
    buffer_load_dwordx4 v216, s[4:7], s31 offen lds
L_site73:
    s_add_u32 m0, s30, 50176
    s_add_u32 s33, s32, 15360
    buffer_load_dwordx4 v217, s[4:7], s31 offen lds
L_site74:
    s_waitcnt lgkmcnt(5)
    v_mfma_f32_32x32x16_bf16 v[160:175], v[0:3], v[192:195], 0
    ds_read_b128 v[8:11], v210 offset:0
    ds_read_b64_tr_b16 v[228:229], v212 offset:8192
    ds_read_b64_tr_b16 v[230:231], v212 offset:9216
    s_add_u32 m0, s30, 114688
    s_add_u32 s27, s27, 1
    buffer_load_dwordx4 v218, s[8:11], s32 offen lds
L_site75:
    s_waitcnt lgkmcnt(7)
    v_mfma_f32_32x32x16_bf16 v[176:191], v[196:199], v[0:3], 0
    ds_read_b128 v[232:235], v237 offset:64
    s_waitcnt lgkmcnt(5)
    v_mfma_f32_32x32x16_bf16 v[160:175], v[4:7], v[200:203], v[160:175]
    ds_read_b128 v[12:15], v211 offset:0
    ds_read_b64_tr_b16 v[192:193], v212 offset:12288
    ds_read_b64_tr_b16 v[194:195], v212 offset:13312
    s_add_u32 m0, s30, 115712
    s_cmp_eq_u32 s27, 10
    s_cselect_b32 s27, 0, s27
    buffer_load_dwordx4 v218, s[8:11], s33 offen lds
L_site76:
    s_waitcnt lgkmcnt(7)
    v_mfma_f32_32x32x16_bf16 v[176:191], v[204:207], v[4:7], v[176:191]
    ds_read_b128 v[196:199], v237 offset:96
    s_waitcnt lgkmcnt(5)
    v_mfma_f32_32x32x16_bf16 v[160:175], v[8:11], v[228:231], v[160:175]
    s_waitcnt vmcnt(8) lgkmcnt(0)
    s_barrier
    ds_read_b128 v[16:19], v208 offset:16384
    ds_read_b64_tr_b16 v[200:201], v212 offset:16384
    ds_read_b64_tr_b16 v[202:203], v212 offset:17408
    s_lshl_b32 s31, s27, 7
    s_add_u32 m0, s30, 0
    s_mul_i32 s32, s27, 245760
    buffer_load_dwordx4 v216, s[4:7], s31 offen lds
L_site77:
    s_waitcnt lgkmcnt(7)
    v_mfma_f32_32x32x16_bf16 v[176:191], v[232:235], v[8:11], v[176:191]
    ds_read_b128 v[204:207], v237 offset:128
    s_waitcnt lgkmcnt(5)
    v_mfma_f32_32x32x16_bf16 v[160:175], v[12:15], v[192:195], v[160:175]
    ds_read_b128 v[20:23], v209 offset:16384
    ds_read_b64_tr_b16 v[228:229], v212 offset:20480
    ds_read_b64_tr_b16 v[230:231], v212 offset:21504
    s_add_u32 m0, s30, 1024
    s_add_u32 s33, s32, 15360
    buffer_load_dwordx4 v217, s[4:7], s31 offen lds
L_site78:
    s_waitcnt lgkmcnt(7)
    v_mfma_f32_32x32x16_bf16 v[176:191], v[196:199], v[12:15], v[176:191]
    ds_read_b128 v[232:235], v237 offset:160
    s_waitcnt lgkmcnt(5)
    v_mfma_f32_32x32x16_bf16 v[160:175], v[16:19], v[200:203], v[160:175]
    ds_read_b128 v[24:27], v210 offset:16384
    ds_read_b64_tr_b16 v[192:193], v212 offset:24576
    ds_read_b64_tr_b16 v[194:195], v212 offset:25600
    s_add_u32 m0, s30, 65536
    s_add_u32 s27, s27, 1
    buffer_load_dwordx4 v218, s[8:11], s32 offen lds
L_site79:
    s_waitcnt lgkmcnt(7)
    v_mfma_f32_32x32x16_bf16 v[176:191], v[204:207], v[16:19], v[176:191]
    ds_read_b128 v[196:199], v237 offset:192
    s_waitcnt lgkmcnt(5)
    v_mfma_f32_32x32x16_bf16 v[160:175], v[20:23], v[228:231], v[160:175]
    ds_read_b128 v[28:31], v211 offset:16384
    ds_read_b64_tr_b16 v[200:201], v212 offset:28672
    ds_read_b64_tr_b16 v[202:203], v212 offset:29696
    s_add_u32 m0, s30, 66560
    s_cmp_eq_u32 s27, 10
    s_cselect_b32 s27, 0, s27
    buffer_load_dwordx4 v218, s[8:11], s33 offen lds
L_site80:
    s_waitcnt lgkmcnt(7)
    v_mfma_f32_32x32x16_bf16 v[176:191], v[232:235], v[20:23], v[176:191]
    ds_read_b128 v[204:207], v237 offset:224
    s_waitcnt lgkmcnt(5)
    v_mfma_f32_32x32x16_bf16 v[160:175], v[24:27], v[192:195], v[160:175]
    s_waitcnt vmcnt(8) lgkmcnt(0)
    s_barrier
    ds_read_b128 v[32:35], v208 offset:32768
    ds_read_b64_tr_b16 v[228:229], v212 offset:32768
    ds_read_b64_tr_b16 v[230:231], v212 offset:33792
    s_lshl_b32 s31, s27, 7
    s_add_u32 m0, s30, 16384
    s_mul_i32 s32, s27, 245760
    buffer_load_dwordx4 v216, s[4:7], s31 offen lds
L_site81:
    s_waitcnt lgkmcnt(7)
    v_mfma_f32_32x32x16_bf16 v[176:191], v[196:199], v[24:27], v[176:191]
    ds_read_b128 v[232:235], v237 offset:256
    s_waitcnt lgkmcnt(5)
    v_mfma_f32_32x32x16_bf16 v[160:175], v[28:31], v[200:203], v[160:175]
    ds_read_b128 v[36:39], v209 offset:32768
    ds_read_b64_tr_b16 v[192:193], v212 offset:36864
    ds_read_b64_tr_b16 v[194:195], v212 offset:37888
    s_add_u32 m0, s30, 17408
    s_add_u32 s33, s32, 15360
    buffer_load_dwordx4 v217, s[4:7], s31 offen lds
L_site82:
    s_waitcnt lgkmcnt(7)
    v_mfma_f32_32x32x16_bf16 v[176:191], v[204:207], v[28:31], v[176:191]
    ds_read_b128 v[196:199], v237 offset:288
    s_waitcnt lgkmcnt(5)
    v_mfma_f32_32x32x16_bf16 v[160:175], v[32:35], v[228:231], v[160:175]
    ds_read_b128 v[40:43], v210 offset:32768
    ds_read_b64_tr_b16 v[200:201], v212 offset:40960
    ds_read_b64_tr_b16 v[202:203], v212 offset:41984
    s_add_u32 m0, s30, 81920
    s_add_u32 s27, s27, 1
    buffer_load_dwordx4 v218, s[8:11], s32 offen lds
L_site83:
    s_waitcnt lgkmcnt(7)
    v_mfma_f32_32x32x16_bf16 v[176:191], v[232:235], v[32:35], v[176:191]
    ds_read_b128 v[204:207], v237 offset:320
    s_waitcnt lgkmcnt(5)
    v_mfma_f32_32x32x16_bf16 v[160:175], v[36:39], v[192:195], v[160:175]
    ds_read_b128 v[44:47], v211 offset:32768
    ds_read_b64_tr_b16 v[228:229], v212 offset:45056
    ds_read_b64_tr_b16 v[230:231], v212 offset:46080
    s_add_u32 m0, s30, 82944
    s_cmp_eq_u32 s27, 10
    s_cselect_b32 s27, 0, s27
    buffer_load_dwordx4 v218, s[8:11], s33 offen lds
L_site84:
    s_waitcnt lgkmcnt(7)
    v_mfma_f32_32x32x16_bf16 v[176:191], v[196:199], v[36:39], v[176:191]
    ds_read_b128 v[232:235], v237 offset:352
    s_waitcnt lgkmcnt(5)
    v_mfma_f32_32x32x16_bf16 v[160:175], v[40:43], v[200:203], v[160:175]
    s_waitcnt vmcnt(8) lgkmcnt(0)
    s_barrier
    ds_read_b128 v[48:51], v208 offset:49152
    ds_read_b64_tr_b16 v[192:193], v212 offset:49152
    ds_read_b64_tr_b16 v[194:195], v212 offset:50176
    s_lshl_b32 s31, s27, 7
    s_add_u32 m0, s30, 32768
    s_mul_i32 s32, s27, 245760
    buffer_load_dwordx4 v216, s[4:7], s31 offen lds
L_site85:
    s_waitcnt lgkmcnt(7)
    v_mfma_f32_32x32x16_bf16 v[176:191], v[204:207], v[40:43], v[176:191]
    ds_read_b128 v[196:199], v237 offset:384
    s_waitcnt lgkmcnt(5)
    v_mfma_f32_32x32x16_bf16 v[160:175], v[44:47], v[228:231], v[160:175]
    ds_read_b128 v[52:55], v209 offset:49152
    ds_read_b64_tr_b16 v[200:201], v212 offset:53248
    ds_read_b64_tr_b16 v[202:203], v212 offset:54272
    s_add_u32 m0, s30, 33792
    s_add_u32 s33, s32, 15360
    buffer_load_dwordx4 v217, s[4:7], s31 offen lds
L_site86:
    s_waitcnt lgkmcnt(7)
    v_mfma_f32_32x32x16_bf16 v[176:191], v[232:235], v[44:47], v[176:191]
    ds_read_b128 v[204:207], v237 offset:416
    s_waitcnt lgkmcnt(5)
    v_mfma_f32_32x32x16_bf16 v[160:175], v[48:51], v[192:195], v[160:175]
    ds_read_b128 v[56:59], v210 offset:49152
    ds_read_b64_tr_b16 v[228:229], v212 offset:57344
    ds_read_b64_tr_b16 v[230:231], v212 offset:58368
    s_add_u32 m0, s30, 98304
    s_add_u32 s27, s27, 1
    buffer_load_dwordx4 v218, s[8:11], s32 offen lds
L_site87:
    s_waitcnt lgkmcnt(7)
    v_mfma_f32_32x32x16_bf16 v[176:191], v[196:199], v[48:51], v[176:191]
    ds_read_b128 v[232:235], v237 offset:448
    s_waitcnt lgkmcnt(5)
    v_mfma_f32_32x32x16_bf16 v[160:175], v[52:55], v[200:203], v[160:175]
    ds_read_b128 v[60:63], v211 offset:49152
    ds_read_b64_tr_b16 v[192:193], v212 offset:61440
    ds_read_b64_tr_b16 v[194:195], v212 offset:62464
    s_add_u32 m0, s30, 99328
    s_cmp_eq_u32 s27, 10
    s_cselect_b32 s27, 0, s27
    buffer_load_dwordx4 v218, s[8:11], s33 offen lds
L_site88:
    s_waitcnt lgkmcnt(7)
    v_mfma_f32_32x32x16_bf16 v[176:191], v[204:207], v[52:55], v[176:191]
    ds_read_b128 v[196:199], v237 offset:480
    s_waitcnt lgkmcnt(5)
    v_mfma_f32_32x32x16_bf16 v[160:175], v[56:59], v[228:231], v[160:175]
    s_waitcnt vmcnt(8) lgkmcnt(0)
    s_barrier
    ds_read_b128 v[64:67], v208 offset:0
    ds_read_b64_tr_b16 v[200:201], v212 offset:0
    ds_read_b64_tr_b16 v[202:203], v212 offset:1024
    s_lshl_b32 s31, s27, 7
    s_add_u32 m0, s30, 49152
    s_mul_i32 s32, s27, 245760
    buffer_load_dwordx4 v216, s[4:7], s31 offen lds
L_site89:
    s_waitcnt lgkmcnt(7)
    v_mfma_f32_32x32x16_bf16 v[176:191], v[232:235], v[56:59], v[176:191]
    ds_read_b128 v[204:207], v237 offset:512
    s_waitcnt lgkmcnt(5)
    v_mfma_f32_32x32x16_bf16 v[160:175], v[60:63], v[192:195], v[160:175]
    ds_read_b128 v[68:71], v209 offset:0
    ds_read_b64_tr_b16 v[228:229], v212 offset:4096
    ds_read_b64_tr_b16 v[230:231], v212 offset:5120
    s_add_u32 m0, s30, 50176
    s_add_u32 s33, s32, 15360
    buffer_load_dwordx4 v217, s[4:7], s31 offen lds
L_site90:
    s_waitcnt lgkmcnt(7)
    v_mfma_f32_32x32x16_bf16 v[176:191], v[196:199], v[60:63], v[176:191]
    ds_read_b128 v[232:235], v237 offset:544
    s_waitcnt lgkmcnt(5)
    v_mfma_f32_32x32x16_bf16 v[160:175], v[64:67], v[200:203], v[160:175]
    ds_read_b128 v[72:75], v210 offset:0
    ds_read_b64_tr_b16 v[192:193], v212 offset:8192
    ds_read_b64_tr_b16 v[194:195], v212 offset:9216
    s_add_u32 m0, s30, 114688
    s_add_u32 s27, s27, 1
    buffer_load_dwordx4 v218, s[8:11], s32 offen lds
L_site91:
    s_waitcnt lgkmcnt(7)
    v_mfma_f32_32x32x16_bf16 v[176:191], v[204:207], v[64:67], v[176:191]
    ds_read_b128 v[196:199], v237 offset:576
    s_waitcnt lgkmcnt(5)
    v_mfma_f32_32x32x16_bf16 v[160:175], v[68:71], v[228:231], v[160:175]
    ds_read_b128 v[76:79], v211 offset:0
    ds_read_b64_tr_b16 v[200:201], v212 offset:12288
    ds_read_b64_tr_b16 v[202:203], v212 offset:13312
    s_add_u32 m0, s30, 115712
    s_cmp_eq_u32 s27, 10
    s_cselect_b32 s27, 0, s27
    buffer_load_dwordx4 v218, s[8:11], s33 offen lds
    global_load_dword v251, v251, s[98:99]
L_site92:
    s_waitcnt lgkmcnt(7)
    v_mfma_f32_32x32x16_bf16 v[176:191], v[232:235], v[68:71], v[176:191]
    ds_read_b128 v[204:207], v237 offset:608
    s_waitcnt lgkmcnt(5)
    v_mfma_f32_32x32x16_bf16 v[160:175], v[72:75], v[192:195], v[160:175]
    s_waitcnt vmcnt(9) lgkmcnt(0)
    s_barrier
    ds_read_b128 v[80:83], v208 offset:16384
    ds_read_b64_tr_b16 v[228:229], v212 offset:16384
    ds_read_b64_tr_b16 v[230:231], v212 offset:17408
    s_lshl_b32 s31, s27, 7
    s_add_u32 m0, s30, 0
    s_mul_i32 s32, s27, 245760
    buffer_load_dwordx4 v216, s[4:7], s31 offen lds
L_site93:
    s_waitcnt lgkmcnt(7)
    v_mfma_f32_32x32x16_bf16 v[176:191], v[196:199], v[72:75], v[176:191]
    ds_read_b128 v[232:235], v237 offset:640
    s_waitcnt lgkmcnt(5)
    v_mfma_f32_32x32x16_bf16 v[160:175], v[76:79], v[200:203], v[160:175]
    ds_read_b128 v[84:87], v209 offset:16384
    ds_read_b64_tr_b16 v[192:193], v212 offset:20480
    ds_read_b64_tr_b16 v[194:195], v212 offset:21504
    s_add_u32 m0, s30, 1024
    s_add_u32 s33, s32, 15360
    buffer_load_dwordx4 v217, s[4:7], s31 offen lds
L_site94:
    s_waitcnt lgkmcnt(7)
    v_mfma_f32_32x32x16_bf16 v[176:191], v[204:207], v[76:79], v[176:191]
    ds_read_b128 v[196:199], v237 offset:672
    s_waitcnt lgkmcnt(5)
    v_mfma_f32_32x32x16_bf16 v[160:175], v[80:83], v[228:231], v[160:175]
    ds_read_b128 v[88:91], v210 offset:16384
    ds_read_b64_tr_b16 v[200:201], v212 offset:24576
    ds_read_b64_tr_b16 v[202:203], v212 offset:25600
    s_add_u32 m0, s30, 65536
    s_add_u32 s27, s27, 1
    buffer_load_dwordx4 v218, s[8:11], s32 offen lds
L_site95:
    s_waitcnt lgkmcnt(7)
    v_mfma_f32_32x32x16_bf16 v[176:191], v[232:235], v[80:83], v[176:191]
    ds_read_b128 v[204:207], v237 offset:704
    s_waitcnt lgkmcnt(5)
    v_mfma_f32_32x32x16_bf16 v[160:175], v[84:87], v[192:195], v[160:175]
    ds_read_b128 v[92:95], v211 offset:16384
    ds_read_b64_tr_b16 v[228:229], v212 offset:28672
    ds_read_b64_tr_b16 v[230:231], v212 offset:29696
    s_add_u32 m0, s30, 66560
    s_cmp_eq_u32 s27, 10
    s_cselect_b32 s27, 0, s27
    buffer_load_dwordx4 v218, s[8:11], s33 offen lds
L_site96:
    s_waitcnt lgkmcnt(7)
    v_mfma_f32_32x32x16_bf16 v[176:191], v[196:199], v[84:87], v[176:191]
    ds_read_b128 v[232:235], v237 offset:736
    s_waitcnt lgkmcnt(5)
    v_mfma_f32_32x32x16_bf16 v[160:175], v[88:91], v[200:203], v[160:175]
    s_waitcnt vmcnt(9) lgkmcnt(0)
    s_barrier
    ds_read_b128 v[96:99], v208 offset:32768
    ds_read_b64_tr_b16 v[192:193], v212 offset:32768
    ds_read_b64_tr_b16 v[194:195], v212 offset:33792
    s_lshl_b32 s31, s27, 7
    s_add_u32 m0, s30, 16384
    s_mul_i32 s32, s27, 245760
    buffer_load_dwordx4 v216, s[4:7], s31 offen lds
L_site97:
    s_waitcnt lgkmcnt(7)
    v_mfma_f32_32x32x16_bf16 v[176:191], v[204:207], v[88:91], v[176:191]
    ds_read_b128 v[196:199], v237 offset:768
    s_waitcnt lgkmcnt(5)
    v_mfma_f32_32x32x16_bf16 v[160:175], v[92:95], v[228:231], v[160:175]
    ds_read_b128 v[100:103], v209 offset:32768
    ds_read_b64_tr_b16 v[200:201], v212 offset:36864
    ds_read_b64_tr_b16 v[202:203], v212 offset:37888
    s_add_u32 m0, s30, 17408
    s_add_u32 s33, s32, 15360
    buffer_load_dwordx4 v217, s[4:7], s31 offen lds
L_site98:
    s_waitcnt lgkmcnt(7)
    v_mfma_f32_32x32x16_bf16 v[176:191], v[232:235], v[92:95], v[176:191]
    ds_read_b128 v[204:207], v237 offset:800
    s_waitcnt lgkmcnt(5)
    v_mfma_f32_32x32x16_bf16 v[160:175], v[96:99], v[192:195], v[160:175]
    ds_read_b128 v[104:107], v210 offset:32768
    ds_read_b64_tr_b16 v[228:229], v212 offset:40960
    ds_read_b64_tr_b16 v[230:231], v212 offset:41984
    s_add_u32 m0, s30, 81920
    s_add_u32 s27, s27, 1
    buffer_load_dwordx4 v218, s[8:11], s32 offen lds
L_site99:
    s_waitcnt lgkmcnt(7)
    v_mfma_f32_32x32x16_bf16 v[176:191], v[196:199], v[96:99], v[176:191]
    ds_read_b128 v[232:235], v237 offset:832
    s_waitcnt lgkmcnt(5)
    v_mfma_f32_32x32x16_bf16 v[160:175], v[100:103], v[200:203], v[160:175]
    ds_read_b128 v[108:111], v211 offset:32768
    ds_read_b64_tr_b16 v[192:193], v212 offset:45056
    ds_read_b64_tr_b16 v[194:195], v212 offset:46080
    s_add_u32 m0, s30, 82944
    s_cmp_eq_u32 s27, 10
    s_cselect_b32 s27, 0, s27
    buffer_load_dwordx4 v218, s[8:11], s33 offen lds
    buffer_load_dwordx2 v[238:239], off, s[52:55], 0
    s_mov_b32 exec_lo, 0x7fff
    s_mov_b32 exec_hi, 0x0
    buffer_load_dword v255, v254, s[12:15], 0 offen
    s_mov_b64 exec, -1
L_site100:
    s_waitcnt lgkmcnt(7)
    v_mfma_f32_32x32x16_bf16 v[176:191], v[204:207], v[100:103], v[176:191]
    ds_read_b128 v[196:199], v237 offset:864
    s_waitcnt lgkmcnt(5)
    v_mfma_f32_32x32x16_bf16 v[160:175], v[104:107], v[228:231], v[160:175]
    s_waitcnt vmcnt(11) lgkmcnt(0)
    s_barrier
    ds_read_b128 v[112:115], v208 offset:49152
    ds_read_b64_tr_b16 v[200:201], v212 offset:49152
    ds_read_b64_tr_b16 v[202:203], v212 offset:50176
    s_waitcnt lgkmcnt(7)
    v_mfma_f32_32x32x16_bf16 v[176:191], v[232:235], v[104:107], v[176:191]
    ds_read_b128 v[204:207], v237 offset:896
    s_waitcnt lgkmcnt(5)
    v_mfma_f32_32x32x16_bf16 v[160:175], v[108:111], v[192:195], v[160:175]
    ds_read_b128 v[116:119], v209 offset:49152
    ds_read_b64_tr_b16 v[228:229], v212 offset:53248
    ds_read_b64_tr_b16 v[230:231], v212 offset:54272
    s_waitcnt lgkmcnt(7)
    v_mfma_f32_32x32x16_bf16 v[176:191], v[196:199], v[108:111], v[176:191]
    ds_read_b128 v[232:235], v237 offset:928
    s_waitcnt lgkmcnt(5)
    v_mfma_f32_32x32x16_bf16 v[160:175], v[112:115], v[200:203], v[160:175]
    ds_read_b128 v[120:123], v210 offset:49152
    ds_read_b64_tr_b16 v[192:193], v212 offset:57344
    ds_read_b64_tr_b16 v[194:195], v212 offset:58368
    s_waitcnt lgkmcnt(7)
    v_mfma_f32_32x32x16_bf16 v[176:191], v[204:207], v[112:115], v[176:191]
    ds_read_b128 v[196:199], v237 offset:960
    s_waitcnt lgkmcnt(5)
    v_mfma_f32_32x32x16_bf16 v[160:175], v[116:119], v[228:231], v[160:175]
    ds_read_b128 v[124:127], v211 offset:49152
    ds_read_b64_tr_b16 v[200:201], v212 offset:61440
    ds_read_b64_tr_b16 v[202:203], v212 offset:62464
    s_waitcnt lgkmcnt(7)
    v_mfma_f32_32x32x16_bf16 v[176:191], v[232:235], v[116:119], v[176:191]
    ds_read_b128 v[204:207], v237 offset:992
    s_waitcnt lgkmcnt(5)
    v_mfma_f32_32x32x16_bf16 v[160:175], v[120:123], v[192:195], v[160:175]
    s_waitcnt vmcnt(6) lgkmcnt(0)
    s_barrier
    ds_read_b128 v[128:131], v208 offset:0
    ds_read_b64_tr_b16 v[228:229], v212 offset:0
    ds_read_b64_tr_b16 v[230:231], v212 offset:1024
    s_mul_i32 s32, s27, 196608
    s_add_u32 m0, s30, 98304
    s_add_u32 s33, s32, 12288
    buffer_load_dwordx4 v219, s[12:15], s32 offen lds
L_site101:
    s_waitcnt lgkmcnt(7)
    v_mfma_f32_32x32x16_bf16 v[176:191], v[196:199], v[120:123], v[176:191]
    ds_read_b128 v[232:235], v237 offset:1024
    s_waitcnt lgkmcnt(5)
    v_mfma_f32_32x32x16_bf16 v[160:175], v[124:127], v[200:203], v[160:175]
    ds_read_b128 v[132:135], v209 offset:0
    ds_read_b64_tr_b16 v[192:193], v212 offset:4096
    ds_read_b64_tr_b16 v[194:195], v212 offset:5120
    s_add_u32 m0, s30, 99328
    s_add_u32 s27, s27, 1
    s_cmp_eq_u32 s27, 10
    s_cselect_b32 s27, 0, s27
    buffer_load_dwordx4 v219, s[12:15], s33 offen lds
L_site102:
    s_waitcnt lgkmcnt(7)
    v_mfma_f32_32x32x16_bf16 v[176:191], v[204:207], v[124:127], v[176:191]
    ds_read_b128 v[196:199], v237 offset:1056
    s_waitcnt lgkmcnt(5)
    v_mfma_f32_32x32x16_bf16 v[160:175], v[128:131], v[228:231], v[160:175]
    ds_read_b128 v[136:139], v210 offset:0
    ds_read_b64_tr_b16 v[200:201], v212 offset:8192
    ds_read_b64_tr_b16 v[202:203], v212 offset:9216
    s_mul_i32 s32, s27, 196608
    s_add_u32 m0, s30, 32768
    s_add_u32 s33, s32, 12288
    buffer_load_dwordx4 v219, s[12:15], s32 offen lds
L_site103:
    s_waitcnt lgkmcnt(7)
    v_mfma_f32_32x32x16_bf16 v[176:191], v[232:235], v[128:131], v[176:191]
    ds_read_b128 v[204:207], v237 offset:1088
    s_waitcnt lgkmcnt(5)
    v_mfma_f32_32x32x16_bf16 v[160:175], v[132:135], v[192:195], v[160:175]
    ds_read_b128 v[140:143], v211 offset:0
    ds_read_b64_tr_b16 v[228:229], v212 offset:12288
    ds_read_b64_tr_b16 v[230:231], v212 offset:13312
    s_add_u32 m0, s30, 33792
    s_add_u32 s27, s27, 1
    s_cmp_eq_u32 s27, 10
    s_cselect_b32 s27, 0, s27
    buffer_load_dwordx4 v219, s[12:15], s33 offen lds
L_site104:
    s_waitcnt lgkmcnt(7)
    v_mfma_f32_32x32x16_bf16 v[176:191], v[196:199], v[132:135], v[176:191]
    ds_read_b128 v[232:235], v237 offset:1120
    s_waitcnt lgkmcnt(5)
    v_mfma_f32_32x32x16_bf16 v[160:175], v[136:139], v[200:203], v[160:175]
    s_waitcnt vmcnt(5) lgkmcnt(0)
    s_barrier
    ds_read_b128 v[144:147], v208 offset:16384
    ds_read_b64_tr_b16 v[192:193], v212 offset:16384
    ds_read_b64_tr_b16 v[194:195], v212 offset:17408
    s_mul_i32 s32, s27, 196608
    s_add_u32 m0, s30, 114688
    s_add_u32 s33, s32, 12288
    buffer_load_dwordx4 v219, s[12:15], s32 offen lds
L_site105:
    s_waitcnt lgkmcnt(7)
    v_mfma_f32_32x32x16_bf16 v[176:191], v[204:207], v[136:139], v[176:191]
    ds_read_b128 v[196:199], v237 offset:1152
    s_waitcnt lgkmcnt(5)
    v_mfma_f32_32x32x16_bf16 v[160:175], v[140:143], v[228:231], v[160:175]
    ds_read_b128 v[148:151], v209 offset:16384
    ds_read_b64_tr_b16 v[200:201], v212 offset:20480
    ds_read_b64_tr_b16 v[202:203], v212 offset:21504
    s_add_u32 m0, s30, 115712
    s_add_u32 s27, s27, 1
    s_cmp_eq_u32 s27, 10
    s_cselect_b32 s27, 0, s27
    buffer_load_dwordx4 v219, s[12:15], s33 offen lds
L_site106:
    s_waitcnt lgkmcnt(7)
    v_mfma_f32_32x32x16_bf16 v[176:191], v[232:235], v[140:143], v[176:191]
    ds_read_b128 v[204:207], v237 offset:1184
    s_waitcnt lgkmcnt(5)
    v_mfma_f32_32x32x16_bf16 v[160:175], v[144:147], v[192:195], v[160:175]
    ds_read_b128 v[152:155], v210 offset:16384
    ds_read_b64_tr_b16 v[228:229], v212 offset:24576
    ds_read_b64_tr_b16 v[230:231], v212 offset:25600
    s_mul_i32 s32, s27, 196608
    s_add_u32 m0, s30, 49152
    s_add_u32 s33, s32, 12288
    buffer_load_dwordx4 v219, s[12:15], s32 offen lds
L_site107:
    s_waitcnt lgkmcnt(7)
    v_mfma_f32_32x32x16_bf16 v[176:191], v[196:199], v[144:147], v[176:191]
    ds_read_b128 v[232:235], v237 offset:1216
    s_waitcnt lgkmcnt(5)
    v_mfma_f32_32x32x16_bf16 v[160:175], v[148:151], v[200:203], v[160:175]
    ds_read_b128 v[156:159], v211 offset:16384
    ds_read_b64_tr_b16 v[192:193], v212 offset:28672
    ds_read_b64_tr_b16 v[194:195], v212 offset:29696
    s_add_u32 m0, s30, 50176
    s_add_u32 s27, s27, 1
    s_cmp_eq_u32 s27, 10
    s_cselect_b32 s27, 0, s27
    buffer_load_dwordx4 v219, s[12:15], s33 offen lds
L_site108:
    s_waitcnt lgkmcnt(7)
    v_mfma_f32_32x32x16_bf16 v[176:191], v[204:207], v[148:151], v[176:191]
    ds_read_b128 v[196:199], v237 offset:1248
    s_waitcnt lgkmcnt(5)
    v_mfma_f32_32x32x16_bf16 v[160:175], v[152:155], v[228:231], v[160:175]
    s_waitcnt vmcnt(4) lgkmcnt(0)
    s_barrier
    s_waitcnt lgkmcnt(4)
    v_mfma_f32_32x32x16_bf16 v[176:191], v[232:235], v[152:155], v[176:191]
    s_waitcnt lgkmcnt(1)
    v_mfma_f32_32x32x16_bf16 v[160:175], v[156:159], v[192:195], v[160:175]
    s_waitcnt lgkmcnt(0)
    v_mfma_f32_32x32x16_bf16 v[176:191], v[196:199], v[156:159], v[176:191]
    s_nop 7
    s_nop 1
    v_cvt_pk_bf16_f32 v224, v160, v161
    v_cvt_pk_bf16_f32 v225, v162, v163
    v_cvt_pk_bf16_f32 v226, v164, v165
    v_cvt_pk_bf16_f32 v227, v166, v167
    s_nop 1
    v_permlane32_swap_b32 v224, v226
    v_permlane32_swap_b32 v225, v227
    buffer_store_dwordx4 v[224:227], v220, s[16:19], 0 offen sc1
    v_cvt_pk_bf16_f32 v240, v168, v169
    v_cvt_pk_bf16_f32 v241, v170, v171
    v_cvt_pk_bf16_f32 v242, v172, v173
    v_cvt_pk_bf16_f32 v243, v174, v175
    s_nop 1
    v_permlane32_swap_b32 v240, v242
    v_permlane32_swap_b32 v241, v243
    buffer_store_dwordx4 v[240:243], v221, s[16:19], 0 offen sc1
    buffer_store_dwordx4 v[244:247], v222, s[16:19], 0 offen sc1
    buffer_store_dwordx4 v[248:251], v223, s[16:19], 0 offen sc1
    v_cvt_pk_bf16_f32 v176, v176, v176
    v_and_b32 v176, 0xffff0000, v176
    v_mul_f32 v176, 0xbfb8aa3b, v176
    v_exp_f32 v176, v176
    s_nop 0
    v_add_f32 v176, 1.0, v176
    v_rcp_f32 v176, v176
    s_lshl_b32 s31, s25, 9
    s_lshl_b32 s32, s35, 7
    v_cvt_pk_bf16_f32 v176, v176, v176
    v_and_b32 v176, 0xffff0000, v176
    s_add_u32 s31, s31, s32
    s_add_u32 s31, s31, 16777216
    v_and_b32 v177, 31, v236
    v_lshlrev_b32 v177, 2, v177
    s_cmp_eq_u32 s26, 15
    s_cbranch_scc0 L_p2
    buffer_store_dword v176, v177, s[16:19], s31 offen sc1
    s_branch L_p2
L_gate:
    s_lshl_b32 s31, s29, 3
    v_add_u32 v220, 0, v236
    v_add_u32 v221, s31, v220
    v_subrev_u32 v222, 80, v221
    v_cmp_le_u32 vcc, 80, v221
    s_lshl_b32 s32, s35, 11
    s_add_u32 m0, s32, 131072
    v_cndmask_b32 v221, v221, v222, vcc
    v_lshlrev_b32 v221, 4, v221
    v_cmp_le_u32 vcc, 80, v220
    s_nop 1
    v_cndmask_b32 v221, v221, v233, vcc
    buffer_load_dwordx4 v221, s[20:23], 0 offen lds
    v_add_u32 v220, 64, v236
    v_add_u32 v221, s31, v220
    v_subrev_u32 v222, 80, v221
    v_cmp_le_u32 vcc, 80, v221
    s_lshl_b32 s32, s35, 11
    s_add_u32 m0, s32, 132096
    v_cndmask_b32 v221, v221, v222, vcc
    v_lshlrev_b32 v221, 4, v221
    v_cmp_le_u32 vcc, 80, v220
    s_nop 1
    v_cndmask_b32 v221, v221, v233, vcc
    buffer_load_dwordx4 v221, s[20:23], 0 offen lds
    s_branch L_gate_ret
L_tag:
    s_memrealtime s[44:45]
    v_mov_b32 v222, 0
    s_waitcnt lgkmcnt(0)
    s_or_b32 s31, s44, 1
    v_mov_b32 v220, s31
    v_mov_b32 v221, s45
    s_mov_b64 exec, 1
    buffer_store_dwordx2 v[220:221], v222, s[52:55], 0 offen sc1
    s_mov_b64 exec, -1
    s_branch L_tag_ret
L_tagw:
    s_mov_b32 s31, 32768
L_tagw_l:
    buffer_load_dwordx2 v[238:239], off, s[52:55], 0 sc1
    s_sub_u32 s31, s31, 1
    s_cmp_eq_u32 s31, 0
    s_cbranch_scc1 L_tagw_ret
    s_waitcnt vmcnt(0)
    v_readfirstlane_b32 s44, v238
    v_readfirstlane_b32 s45, v239
    s_nop 0
    s_cmp_eq_u32 s44, 0
    s_cbranch_scc1 L_tagw_l
    s_branch L_tagw_ret
L_late2:
    s_barrier
    buffer_load_dwordx4 v[96:99], v255, s[16:19], s32 offen sc1
    buffer_load_dwordx4 v[100:103], v255, s[16:19], s32 offen offset:1024 sc1
    buffer_load_dwordx4 v[108:111], v12, s[16:19], s33 offen sc1
    s_branch L_late2_ret
L_w2:
    s_mov_b32 s31, 32768
L_w2_l:
    buffer_load_dwordx4 v[128:131], v251, s[16:19], 0 offen sc1
    s_sub_u32 s31, s31, 1
    s_cmp_eq_u32 s31, 0
    s_cbranch_scc1 L_w2_ret
    s_waitcnt vmcnt(0)
    v_cmp_ne_u64 vcc, s[44:45], v[128:129]
    v_cmp_ne_u64 s[40:41], s[44:45], v[130:131]
    s_nop 0
    s_or_b64 vcc, vcc, s[40:41]
    s_cbranch_vccnz L_w2_l
    s_branch L_w2_ret
L_at_slow:
    v_mov_b32 v44, v120
    v_mov_b32 v45, v121
    v_mov_b32 v32, 0
    v_mov_b32 v33, 0
    v_mov_b32 v34, 0
    v_mov_b32 v35, 0
    v_mov_b32 v36, 0
    v_mov_b32 v37, 0
    v_mov_b32 v38, 0
    v_mov_b32 v39, 0
    v_mov_b32 v40, 0
    v_mov_b32 v41, 0
    v_permlane32_swap_b32 v120, v44
    v_permlane32_swap_b32 v121, v45
    s_cmp_eq_u32 s27, 0
    s_cbranch_scc1 L_slow_z0
    s_nop 0
    v_mov_b32 v120, v44
    v_mov_b32 v121, v45
    v_mov_b32 v96, v100
    v_mov_b32 v97, v101
    v_mov_b32 v98, v102
    v_mov_b32 v99, v103
L_slow_z0:
    s_mov_b32 exec_hi, 0
    v_mov_b32 v34, v120
    v_mov_b32 v35, v121
    s_mov_b64 exec, -1
    s_mov_b32 exec_lo, 0
    v_mov_b32 v38, v120
    v_mov_b32 v39, v121
    s_mov_b64 exec, -1
    s_mul_i32 s34, s27, 81920
    s_add_u32 s34, s34, 46080
    v_subrev_u32 v52, s34, v253
    v_mov_b32 v53, 0xff7fffff
    v_mov_b32 v16, 0
    v_mov_b32 v17, 0
    v_mov_b32 v18, 0
    v_mov_b32 v19, 0
    v_mov_b32 v20, 0
    v_mov_b32 v21, 0
    v_mov_b32 v22, 0
    v_mov_b32 v23, 0
    v_mov_b32 v24, 0
    v_mov_b32 v25, 0
    v_mov_b32 v26, 0
    v_mov_b32 v27, 0
    v_mov_b32 v28, 0
    v_mov_b32 v29, 0
    v_mov_b32 v30, 0
    v_mov_b32 v31, 0
    v_mov_b32 v64, 0
    v_mov_b32 v65, 0
    v_mov_b32 v66, 0
    v_mov_b32 v67, 0
    v_mov_b32 v68, 0
    v_mov_b32 v69, 0
    v_mov_b32 v70, 0
    v_mov_b32 v71, 0
    v_mov_b32 v72, 0
    v_mov_b32 v73, 0
    v_mov_b32 v74, 0
    v_mov_b32 v75, 0
    v_mov_b32 v76, 0
    v_mov_b32 v77, 0
    v_mov_b32 v78, 0
    v_mov_b32 v79, 0
    s_mul_i32 s34, s25, 163840
    s_add_u32 s34, s34, 2621440
    s_mov_b32 s35, 16
L_slow_loop0:
    s_add_u32 s36, s34, 4096
    buffer_load_dwordx4 v[108:111], v255, s[16:19], s36 offen sc1
    buffer_load_dwordx4 v[44:47], v255, s[16:19], s34 offen offset:0 sc1
    s_waitcnt vmcnt(0)
    v_mfma_f32_32x32x16_bf16 v[0:15], v[44:47], v[96:99], v[16:31]
    v_mfma_f32_32x32x16_bf16 v[0:15], v[108:111], v[34:37], v[0:15]
    s_nop 11
    v_max3_f32 v53, v53, v0, v1
    v_max3_f32 v53, v53, v2, v3
    v_max3_f32 v53, v53, v4, v5
    v_max3_f32 v53, v53, v6, v7
    v_max3_f32 v53, v53, v8, v9
    v_max3_f32 v53, v53, v10, v11
    v_max3_f32 v53, v53, v12, v13
    v_max3_f32 v53, v53, v14, v15
    buffer_load_dwordx4 v[44:47], v255, s[16:19], s34 offen offset:1024 sc1
    s_waitcnt vmcnt(0)
    v_mfma_f32_32x32x16_bf16 v[0:15], v[44:47], v[96:99], v[16:31]
    v_mfma_f32_32x32x16_bf16 v[0:15], v[108:111], v[32:35], v[0:15]
    s_nop 11
    v_max3_f32 v53, v53, v0, v1
    v_max3_f32 v53, v53, v2, v3
    v_max3_f32 v53, v53, v4, v5
    v_max3_f32 v53, v53, v6, v7
    v_max3_f32 v53, v53, v8, v9
    v_max3_f32 v53, v53, v10, v11
    v_max3_f32 v53, v53, v12, v13
    v_max3_f32 v53, v53, v14, v15
    buffer_load_dwordx4 v[44:47], v255, s[16:19], s34 offen offset:2048 sc1
    s_waitcnt vmcnt(0)
    v_mfma_f32_32x32x16_bf16 v[0:15], v[44:47], v[96:99], v[16:31]
    v_mfma_f32_32x32x16_bf16 v[0:15], v[108:111], v[38:41], v[0:15]
    s_nop 11
    v_max3_f32 v53, v53, v0, v1
    v_max3_f32 v53, v53, v2, v3
    v_max3_f32 v53, v53, v4, v5
    v_max3_f32 v53, v53, v6, v7
    v_max3_f32 v53, v53, v8, v9
    v_max3_f32 v53, v53, v10, v11
    v_max3_f32 v53, v53, v12, v13
    v_max3_f32 v53, v53, v14, v15
    buffer_load_dwordx4 v[44:47], v255, s[16:19], s34 offen offset:3072 sc1
    s_waitcnt vmcnt(0)
    v_mfma_f32_32x32x16_bf16 v[0:15], v[44:47], v[96:99], v[16:31]
    v_mfma_f32_32x32x16_bf16 v[0:15], v[108:111], v[36:39], v[0:15]
    s_nop 11
    v_max3_f32 v53, v53, v0, v1
    v_max3_f32 v53, v53, v2, v3
    v_max3_f32 v53, v53, v4, v5
    v_max3_f32 v53, v53, v6, v7
    v_max3_f32 v53, v53, v8, v9
    v_max3_f32 v53, v53, v10, v11
    v_max3_f32 v53, v53, v12, v13
    v_max3_f32 v53, v53, v14, v15
    s_add_u32 s34, s34, 10240
    s_sub_u32 s35, s35, 1
    s_cmp_lg_u32 s35, 0
    s_cbranch_scc1 L_slow_loop0
    v_mov_b32 v107, v53
    v_mov_b32 v105, v53
    s_nop 1
    v_permlane32_swap_b32 v107, v105
    s_nop 1
    v_max_f32 v53, v107, v105
    v_sub_f32 v16, 0, v53
    v_sub_f32 v17, 0, v53
    v_sub_f32 v18, 0, v53
    v_sub_f32 v19, 0, v53
    v_sub_f32 v20, 0, v53
    v_sub_f32 v21, 0, v53
    v_sub_f32 v22, 0, v53
    v_sub_f32 v23, 0, v53
    v_sub_f32 v24, 0, v53
    v_sub_f32 v25, 0, v53
    v_sub_f32 v26, 0, v53
    v_sub_f32 v27, 0, v53
    v_sub_f32 v28, 0, v53
    v_sub_f32 v29, 0, v53
    v_sub_f32 v30, 0, v53
    v_sub_f32 v31, 0, v53
    s_mul_i32 s34, s25, 163840
    s_add_u32 s34, s34, 2621440
    s_mov_b32 s35, 16
L_slow_loop1:
    s_add_u32 s36, s34, 4096
    buffer_load_dwordx4 v[108:111], v255, s[16:19], s36 offen sc1
    buffer_load_dwordx4 v[44:47], v255, s[16:19], s34 offen offset:0 sc1
    s_add_u32 s36, s34, 5120
    s_mov_b64 exec, s[38:39]
    buffer_load_dwordx4 v[112:115], v52, s[16:19], s36 offen sc1
    buffer_load_dwordx4 v[116:119], v52, s[16:19], s36 offen offset:640 sc1
    s_mov_b64 exec, -1
    s_waitcnt vmcnt(0)
    v_mfma_f32_32x32x16_bf16 v[0:15], v[44:47], v[96:99], v[16:31]
    v_mfma_f32_32x32x16_bf16 v[0:15], v[108:111], v[34:37], v[0:15]
    s_nop 11
    v_exp_f32 v0, v0
    v_exp_f32 v1, v1
    v_exp_f32 v2, v2
    v_exp_f32 v3, v3
    v_exp_f32 v4, v4
    v_exp_f32 v5, v5
    v_exp_f32 v6, v6
    v_exp_f32 v7, v7
    v_exp_f32 v8, v8
    v_exp_f32 v9, v9
    v_exp_f32 v10, v10
    v_exp_f32 v11, v11
    v_exp_f32 v12, v12
    v_exp_f32 v13, v13
    v_exp_f32 v14, v14
    v_exp_f32 v15, v15
    s_nop 1
    v_smfmac_f32_32x32x32_bf16 v[64:79], v[112:115], v[0:7], v122
    v_smfmac_f32_32x32x32_bf16 v[64:79], v[116:119], v[8:15], v122
    s_nop 3
    buffer_load_dwordx4 v[44:47], v255, s[16:19], s34 offen offset:1024 sc1
    s_add_u32 s36, s34, 6400
    s_mov_b64 exec, s[38:39]
    buffer_load_dwordx4 v[112:115], v52, s[16:19], s36 offen sc1
    buffer_load_dwordx4 v[116:119], v52, s[16:19], s36 offen offset:640 sc1
    s_mov_b64 exec, -1
    s_waitcnt vmcnt(0)
    v_mfma_f32_32x32x16_bf16 v[0:15], v[44:47], v[96:99], v[16:31]
    v_mfma_f32_32x32x16_bf16 v[0:15], v[108:111], v[32:35], v[0:15]
    s_nop 11
    v_exp_f32 v0, v0
    v_exp_f32 v1, v1
    v_exp_f32 v2, v2
    v_exp_f32 v3, v3
    v_exp_f32 v4, v4
    v_exp_f32 v5, v5
    v_exp_f32 v6, v6
    v_exp_f32 v7, v7
    v_exp_f32 v8, v8
    v_exp_f32 v9, v9
    v_exp_f32 v10, v10
    v_exp_f32 v11, v11
    v_exp_f32 v12, v12
    v_exp_f32 v13, v13
    v_exp_f32 v14, v14
    v_exp_f32 v15, v15
    s_nop 1
    v_smfmac_f32_32x32x32_bf16 v[64:79], v[112:115], v[0:7], v122
    v_smfmac_f32_32x32x32_bf16 v[64:79], v[116:119], v[8:15], v122
    s_nop 3
    buffer_load_dwordx4 v[44:47], v255, s[16:19], s34 offen offset:2048 sc1
    s_add_u32 s36, s34, 7680
    s_mov_b64 exec, s[38:39]
    buffer_load_dwordx4 v[112:115], v52, s[16:19], s36 offen sc1
    buffer_load_dwordx4 v[116:119], v52, s[16:19], s36 offen offset:640 sc1
    s_mov_b64 exec, -1
    s_waitcnt vmcnt(0)
    v_mfma_f32_32x32x16_bf16 v[0:15], v[44:47], v[96:99], v[16:31]
    v_mfma_f32_32x32x16_bf16 v[0:15], v[108:111], v[38:41], v[0:15]
    s_nop 11
    v_exp_f32 v0, v0
    v_exp_f32 v1, v1
    v_exp_f32 v2, v2
    v_exp_f32 v3, v3
    v_exp_f32 v4, v4
    v_exp_f32 v5, v5
    v_exp_f32 v6, v6
    v_exp_f32 v7, v7
    v_exp_f32 v8, v8
    v_exp_f32 v9, v9
    v_exp_f32 v10, v10
    v_exp_f32 v11, v11
    v_exp_f32 v12, v12
    v_exp_f32 v13, v13
    v_exp_f32 v14, v14
    v_exp_f32 v15, v15
    s_nop 1
    v_smfmac_f32_32x32x32_bf16 v[64:79], v[112:115], v[0:7], v122
    v_smfmac_f32_32x32x32_bf16 v[64:79], v[116:119], v[8:15], v122
    s_nop 3
    buffer_load_dwordx4 v[44:47], v255, s[16:19], s34 offen offset:3072 sc1
    s_add_u32 s36, s34, 8960
    s_mov_b64 exec, s[38:39]
    buffer_load_dwordx4 v[112:115], v52, s[16:19], s36 offen sc1
    buffer_load_dwordx4 v[116:119], v52, s[16:19], s36 offen offset:640 sc1
    s_mov_b64 exec, -1
    s_waitcnt vmcnt(0)
    v_mfma_f32_32x32x16_bf16 v[0:15], v[44:47], v[96:99], v[16:31]
    v_mfma_f32_32x32x16_bf16 v[0:15], v[108:111], v[36:39], v[0:15]
    s_nop 11
    v_exp_f32 v0, v0
    v_exp_f32 v1, v1
    v_exp_f32 v2, v2
    v_exp_f32 v3, v3
    v_exp_f32 v4, v4
    v_exp_f32 v5, v5
    v_exp_f32 v6, v6
    v_exp_f32 v7, v7
    v_exp_f32 v8, v8
    v_exp_f32 v9, v9
    v_exp_f32 v10, v10
    v_exp_f32 v11, v11
    v_exp_f32 v12, v12
    v_exp_f32 v13, v13
    v_exp_f32 v14, v14
    v_exp_f32 v15, v15
    s_nop 1
    v_smfmac_f32_32x32x32_bf16 v[64:79], v[112:115], v[0:7], v122
    v_smfmac_f32_32x32x32_bf16 v[64:79], v[116:119], v[8:15], v122
    s_nop 3
    s_add_u32 s34, s34, 10240
    s_sub_u32 s35, s35, 1
    s_cmp_lg_u32 s35, 0
    s_cbranch_scc1 L_slow_loop1
    s_nop 11
    v_mov_b32 v106, v72
    v_mov_b32 v107, v72
    s_nop 1
    v_permlane32_swap_b32 v107, v106
    s_nop 1
    v_rcp_f32 v105, v106
    s_nop 0
    s_branch L_at_store
L_or11:
    s_mov_b32 s31, 32768
    v_bfe_u32 v241, v255, 4, 5
    v_lshlrev_b32 v241, 9, v241
    s_lshl_b32 s13, s3, 8
    s_and_b32 s41, s15, 0xffffc000
    s_add_u32 s13, s13, s41
L_or11_l:
    s_sub_u32 s31, s31, 1
    s_cmp_eq_u32 s31, 0
    s_cbranch_scc1 L_or11_ret
    buffer_load_dword v121, v241, s[16:19], s13 offen sc1
    s_waitcnt vmcnt(0)
    v_cmp_eq_u32 vcc, -1, v121
    s_nop 0
    s_cbranch_vccnz L_or11_l
    s_add_u32 s41, s59, 0
    buffer_load_dwordx4 v[0:3], v249, s[16:19], s41 offen offset:0 sc1
    buffer_load_dwordx4 v[4:7], v240, s[16:19], s41 offen offset:0 sc1
    s_add_u32 s41, s59, 8192
    buffer_load_dwordx4 v[8:11], v249, s[16:19], s41 offen offset:0 sc1
    buffer_load_dwordx4 v[12:15], v240, s[16:19], s41 offen offset:0 sc1
    s_add_u32 s41, s59, 16384
    buffer_load_dwordx4 v[16:19], v249, s[16:19], s41 offen offset:0 sc1
    buffer_load_dwordx4 v[20:23], v240, s[16:19], s41 offen offset:0 sc1
    s_add_u32 s41, s59, 24576
    buffer_load_dwordx4 v[24:27], v249, s[16:19], s41 offen offset:0 sc1
    buffer_load_dwordx4 v[28:31], v240, s[16:19], s41 offen offset:0 sc1
    buffer_load_dwordx4 v[32:35], v120, s[16:19], s15 offen offset:0 sc1
    buffer_load_dwordx4 v[36:39], v120, s[16:19], s15 offen offset:512 sc1
    s_waitcnt vmcnt(0)
    v_max3_u32 v121, v0, v1, v2
    v_max3_u32 v121, v121, v3, v4
    v_max3_u32 v121, v121, v5, v6
    v_max3_u32 v121, v121, v7, v7
    v_cmp_eq_u32 vcc, -1, v121
    s_nop 0
    s_cbranch_vccnz L_or11_l
    s_branch L_or11_ret
L_or12:
    s_mov_b32 s31, 32768
    v_bfe_u32 v241, v255, 4, 5
    v_lshlrev_b32 v241, 9, v241
    s_lshl_b32 s13, s3, 8
    s_and_b32 s41, s15, 0xffffc000
    s_add_u32 s13, s13, s41
L_or12_l:
    s_sub_u32 s31, s31, 1
    s_cmp_eq_u32 s31, 0
    s_cbranch_scc1 L_or12_ret
    buffer_load_dword v121, v241, s[16:19], s13 offen sc1
    s_waitcnt vmcnt(0)
    v_cmp_eq_u32 vcc, -1, v121
    s_nop 0
    s_cbranch_vccnz L_or12_l
    s_add_u32 s41, s59, 8192
    buffer_load_dwordx4 v[8:11], v249, s[16:19], s41 offen offset:0 sc1
    buffer_load_dwordx4 v[12:15], v240, s[16:19], s41 offen offset:0 sc1
    s_add_u32 s41, s59, 16384
    buffer_load_dwordx4 v[16:19], v249, s[16:19], s41 offen offset:0 sc1
    buffer_load_dwordx4 v[20:23], v240, s[16:19], s41 offen offset:0 sc1
    s_add_u32 s41, s59, 24576
    buffer_load_dwordx4 v[24:27], v249, s[16:19], s41 offen offset:0 sc1
    buffer_load_dwordx4 v[28:31], v240, s[16:19], s41 offen offset:0 sc1
    buffer_load_dwordx4 v[32:35], v120, s[16:19], s15 offen offset:0 sc1
    buffer_load_dwordx4 v[36:39], v120, s[16:19], s15 offen offset:512 sc1
    s_waitcnt vmcnt(0)
    v_max3_u32 v121, v8, v9, v10
    v_max3_u32 v121, v121, v11, v12
    v_max3_u32 v121, v121, v13, v14
    v_max3_u32 v121, v121, v15, v15
    v_cmp_eq_u32 vcc, -1, v121
    s_nop 0
    s_cbranch_vccnz L_or12_l
    s_branch L_or12_ret
L_or13:
    s_mov_b32 s31, 32768
    v_bfe_u32 v241, v255, 4, 5
    v_lshlrev_b32 v241, 9, v241
    s_lshl_b32 s13, s3, 8
    s_and_b32 s41, s15, 0xffffc000
    s_add_u32 s13, s13, s41
L_or13_l:
    s_sub_u32 s31, s31, 1
    s_cmp_eq_u32 s31, 0
    s_cbranch_scc1 L_or13_ret
    buffer_load_dword v121, v241, s[16:19], s13 offen sc1
    s_waitcnt vmcnt(0)
    v_cmp_eq_u32 vcc, -1, v121
    s_nop 0
    s_cbranch_vccnz L_or13_l
    s_add_u32 s41, s59, 16384
    buffer_load_dwordx4 v[16:19], v249, s[16:19], s41 offen offset:0 sc1
    buffer_load_dwordx4 v[20:23], v240, s[16:19], s41 offen offset:0 sc1
    s_add_u32 s41, s59, 24576
    buffer_load_dwordx4 v[24:27], v249, s[16:19], s41 offen offset:0 sc1
    buffer_load_dwordx4 v[28:31], v240, s[16:19], s41 offen offset:0 sc1
    buffer_load_dwordx4 v[32:35], v120, s[16:19], s15 offen offset:0 sc1
    buffer_load_dwordx4 v[36:39], v120, s[16:19], s15 offen offset:512 sc1
    s_waitcnt vmcnt(0)
    v_max3_u32 v121, v16, v17, v18
    v_max3_u32 v121, v121, v19, v20
    v_max3_u32 v121, v121, v21, v22
    v_max3_u32 v121, v121, v23, v23
    v_cmp_eq_u32 vcc, -1, v121
    s_nop 0
    s_cbranch_vccnz L_or13_l
    s_branch L_or13_ret
L_or14:
    s_mov_b32 s31, 32768
    v_bfe_u32 v241, v255, 4, 5
    v_lshlrev_b32 v241, 9, v241
    s_lshl_b32 s13, s3, 8
    s_and_b32 s41, s15, 0xffffc000
    s_add_u32 s13, s13, s41
L_or14_l:
    s_sub_u32 s31, s31, 1
    s_cmp_eq_u32 s31, 0
    s_cbranch_scc1 L_or14_ret
    buffer_load_dword v121, v241, s[16:19], s13 offen sc1
    s_waitcnt vmcnt(0)
    v_cmp_eq_u32 vcc, -1, v121
    s_nop 0
    s_cbranch_vccnz L_or14_l
    s_add_u32 s41, s59, 24576
    buffer_load_dwordx4 v[24:27], v249, s[16:19], s41 offen offset:0 sc1
    buffer_load_dwordx4 v[28:31], v240, s[16:19], s41 offen offset:0 sc1
    buffer_load_dwordx4 v[32:35], v120, s[16:19], s15 offen offset:0 sc1
    buffer_load_dwordx4 v[36:39], v120, s[16:19], s15 offen offset:512 sc1
    s_waitcnt vmcnt(0)
    v_max3_u32 v121, v24, v25, v26
    v_max3_u32 v121, v121, v27, v28
    v_max3_u32 v121, v121, v29, v30
    v_max3_u32 v121, v121, v31, v32
    v_max3_u32 v121, v121, v33, v34
    v_max3_u32 v121, v121, v35, v36
    v_max3_u32 v121, v121, v37, v38
    v_max3_u32 v121, v121, v39, v39
    v_cmp_eq_u32 vcc, -1, v121
    s_nop 0
    s_cbranch_vccnz L_or14_l
    s_branch L_or14_ret
L_late1:
    s_cmp_eq_u32 s24, 4
    s_cbranch_scc0 L_w1_ret
    s_waitcnt vmcnt(1)
    v_cmp_ne_u64 vcc, s[44:45], v[16:17]
    v_cmp_ne_u64 s[46:47], s[44:45], v[18:19]
    s_nop 0
    s_or_b64 vcc, vcc, s[46:47]
    s_cbranch_vccz L_w1_ret
    s_waitcnt vmcnt(0)
    v_cmp_ne_u64 vcc, s[44:45], v[220:221]
    v_cmp_ne_u64 s[46:47], s[44:45], v[222:223]
    s_nop 0
    s_or_b64 vcc, vcc, s[46:47]
    s_cbranch_vccnz L_w1
L_w1_ret:
    s_barrier
    s_mov_b32 m0, s35
    s_add_u32 s37, s35, s36
    buffer_load_dwordx4 v255, s[16:19], s37 offen offset:0 sc1 lds
    buffer_load_dwordx4 v255, s[16:19], s37 offen offset:1024 sc1 lds
    buffer_load_dwordx4 v255, s[16:19], s37 offen offset:2048 sc1 lds
    buffer_load_dwordx4 v255, s[16:19], s37 offen offset:3072 sc1 lds
    s_add_u32 m0, s35, 4096
    s_add_u32 s37, s37, 4096
    buffer_load_dwordx4 v255, s[16:19], s37 offen offset:0 sc1 lds
    buffer_load_dwordx4 v[96:99], v255, s[16:19], s32 offen sc1
    buffer_load_dwordx4 v[100:103], v255, s[16:19], s32 offen offset:1024 sc1
    buffer_load_dwordx4 v[108:111], v12, s[16:19], s33 offen sc1
    s_branch L_late1_ret
L_w1:
    s_mov_b32 s31, 32768
L_w1_l:
    buffer_load_dwordx4 v[220:223], v254, s[16:19], 0 offen sc1
    s_sub_u32 s31, s31, 1
    s_cmp_eq_u32 s31, 0
    s_cbranch_scc1 L_w1_ret
    s_waitcnt vmcnt(0)
    v_cmp_ne_u64 vcc, s[44:45], v[220:221]
    v_cmp_ne_u64 s[46:47], s[44:45], v[222:223]
    s_nop 0
    s_or_b64 vcc, vcc, s[46:47]
    s_cbranch_vccnz L_w1_l
    s_branch L_w1_ret
L_code_end:
.section .rodata,"a"
.p2align 6
.amdhsa_kernel gated_mix__mha_block__dense_activation_relu__prompt_kernel
  .amdhsa_next_free_vgpr 256
  .amdhsa_next_free_sgpr 100
  .amdhsa_accum_offset 256
  .amdhsa_group_segment_fixed_size 0
  .amdhsa_kernarg_size 80
  .amdhsa_user_sgpr_count 2
  .amdhsa_user_sgpr_kernarg_segment_ptr 1
  .amdhsa_system_sgpr_workgroup_id_x 1
.end_amdhsa_kernel
```
